```python
import torch

def _softmax(x, axis=-1):
    return torch.softmax(x, dim=axis)
def _gelu(x):
    return torch.nn.functional.gelu(x, approximate="tanh")
def _silu(x):
    return torch.nn.functional.silu(x)
def _sigmoid(x):
    return torch.sigmoid(x)
def _layernorm(x, axis=-1, eps=1e-5):
    m = x.mean(dim=axis, keepdim=True)
    v = x.var(dim=axis, keepdim=True, unbiased=False)
    return (x - m) / torch.sqrt(v + eps)
def _scatter_add(tgt, idx, src, axis=0):
    return tgt.clone().index_add_(axis, idx, src)
def _segment_sum(src, seg, n):
    out = torch.zeros((n,) + src.shape[1:], dtype=src.dtype)
    return out.index_add_(0, seg, src)
def _pad(x, pw):
    flat = tuple(v for pair in reversed(pw) for v in pair)
    return torch.nn.functional.pad(x, flat)

kernel_name = 'interleave_layers__grouped_kv_mqa__dense_activation_gelu__prompt'

def setup_inputs():

    _w = (lambda a: (lambda t: t.to(torch.bfloat16) if t.is_floating_point() else t)(torch.as_tensor(a)))
    def _A_setup():
        B, S, D, H = 1, 2048, 512, 32
        Dh = D // H
        return {
            "x": _w((lambda *s: torch.randn(*s, dtype=torch.bfloat16) * 0.05)(B, S, D)),
            "wq": _w((lambda *s: torch.randn(*s, dtype=torch.bfloat16) * 0.05)(D, H * Dh)),
            "wk": _w((lambda *s: torch.randn(*s, dtype=torch.bfloat16) * 0.05)(D, Dh)),
            "wv": _w((lambda *s: torch.randn(*s, dtype=torch.bfloat16) * 0.05)(D, Dh)),
            "wo": _w((lambda *s: torch.randn(*s, dtype=torch.bfloat16) * 0.05)(H * Dh, D)),
        }
    _A_in = _A_setup()

    def _B_setup():
        B, S, D, F = 1, 2048, 512, 1376
        return {
            "x": _w((lambda *s: torch.randn(*s, dtype=torch.bfloat16) * 0.05)(B, S, D)),
            "w1": _w((lambda *s: torch.randn(*s, dtype=torch.bfloat16) * 0.8)(D, F) * (D ** -0.5)),
            "b1": _w((lambda *s: torch.randn(*s, dtype=torch.bfloat16) * 12.8)(F) * 0.01),
            "w2": _w((lambda *s: torch.randn(*s, dtype=torch.bfloat16) * 0.2)(F, D) * (F ** -0.5)),
            "b2": _w((lambda *s: torch.randn(*s, dtype=torch.bfloat16) * 1.6)(D) * 0.01),
        }
    _B_in = _B_setup()

    return {
        "A_x": _A_in["x"],
        "A_wq": _A_in["wq"],
        "A_wk": _A_in["wk"],
        "A_wv": _A_in["wv"],
        "A_wo": _A_in["wo"],
        "B_x": _B_in["x"],
        "B_w1": _B_in["w1"],
        "B_b1": _B_in["b1"],
        "B_w2": _B_in["w2"],
        "B_b2": _B_in["b2"],
    }

def reference(A_x, A_wq, A_wk, A_wv, A_wo, B_x, B_w1, B_b1, B_w2, B_b2):
    def _A_ref(x, wq, wk, wv, wo):
        B, S, D = x.shape
        H = 32
        Dh = D // H
        q = (lambda x, *d: x.permute(*d))((x @ wq).reshape(B, S, H, Dh), 0, 2, 1, 3)
        k = x @ wk
        v = x @ wv
        scores = torch.einsum("bhqd,bkd->bhqk", q, k) * (Dh ** -0.5)
        p = _softmax(scores, axis=-1)
        o = torch.einsum("bhqk,bkd->bhqd", p, v)
        return (lambda x, *d: x.permute(*d))(o, 0, 2, 1, 3).reshape(B, S, H * Dh) @ wo

    def _B_ref(x, w1, b1, w2, b2):
        h = torch.einsum("bsd,df->bsf", x, w1) + b1
        h = _gelu(h)
        return torch.einsum("bsf,fd->bsd", h, w2) + b2

    x = A_x
    x = x + _A_ref(_layernorm(x, axis=-1), A_wq, A_wk, A_wv, A_wo)
    x = x + _B_ref(_layernorm(x, axis=-1), B_w1, B_b1, B_w2, B_b2)
    x = x + _A_ref(_layernorm(x, axis=-1), A_wq, A_wk, A_wv, A_wo)
    x = x + _B_ref(_layernorm(x, axis=-1), B_w1, B_b1, B_w2, B_b2)
    return x
```

```asm
; @launch kernel=prep_kernel grid=(183,1,1) block=(512,1,1) lds=4096
; @launch kernel=attn_kernel grid=(256,1,1) block=(512,1,1) lds=98304
; @launch kernel=layer2_kernel grid=(256,1,1) block=(512,1,1) lds=98304
.amdgcn_target "amdgcn-amd-amdhsa--gfx950"
.text
.globl prep_kernel
.p2align 8
.type prep_kernel,@function
prep_kernel:
    s_load_dwordx2 s[20:21], s[0:1], 96
    s_load_dwordx4 s[24:27], s[0:1], 0
    s_load_dwordx4 s[28:31], s[0:1], 16
    s_load_dwordx2 s[32:33], s[0:1], 32
    s_load_dwordx4 s[36:39], s[0:1], 48
    s_load_dwordx2 s[34:35], s[0:1], 64
    v_lshrrev_b32 v1, 6, v0
    v_and_b32 v2, 15, v0
    v_readfirstlane_b32 s3, v1
    v_bfe_u32 v3, v0, 4, 1
    v_bfe_u32 v4, v0, 5, 1
    v_lshlrev_b32 v5, 4, v4
    v_lshl_add_u32 v5, v3, 2, v5
    v_lshlrev_b32 v7, 10, v4
    v_lshl_add_u32 v7, v3, 9, v7
    v_lshl_add_u32 v7, v2, 5, v7
    s_mov_b32 s18, 0x05040100
    s_mov_b32 s19, 0x07060302
    s_mov_b32 s23, 0x3f803f80
    s_mov_b32 s22, 0
    s_waitcnt lgkmcnt(0)
    s_mov_b32 s4, s20
    s_mov_b32 s5, s21
    s_mov_b32 s6, 18718720
    s_mov_b32 s7, 0x20000
    s_cmp_ge_u32 s2, 43
    s_cbranch_scc1 prep_kernel_n6
    s_mov_b32 s8, s36
    s_mov_b32 s9, s37
    s_mov_b32 s10, 1409024
    s_mov_b32 s11, 0x20000
    s_mov_b32 s60, s38
    s_mov_b32 s61, s39
    s_mov_b32 s62, 2752
    s_mov_b32 s63, 0x20000
    s_sub_u32 s12, s2, 0
    s_mov_b32 s13, 2752
    s_mul_i32 s14, s12, 64
    s_mul_i32 s15, s3, 176128
    s_add_u32 s14, s14, s15
    s_mul_i32 s16, s12, 32768
    s_mul_i32 s15, s3, 4096
    s_add_u32 s16, s16, s15
    s_add_u32 s16, s16, 524288
    s_add_u32 s17, s16, 2048
    s_mov_b32 s15, 88064
    s_lshl_b32 s22, s12, 10
    s_add_u32 s22, s22, 1950720
    s_branch prep_kernel_pack1
prep_kernel_n6:
    s_cmp_ge_u32 s2, 59
    s_cbranch_scc1 prep_kernel_n7
    s_mov_b32 s8, s26
    s_mov_b32 s9, s27
    s_mov_b32 s10, 524288
    s_mov_b32 s11, 0x20000
    s_mov_b32 s60, s38
    s_mov_b32 s61, s39
    s_mov_b32 s62, 0
    s_mov_b32 s63, 0x20000
    s_sub_u32 s12, s2, 43
    s_mov_b32 s13, 1024
    s_mul_i32 s14, s12, 64
    s_mul_i32 s15, s3, 65536
    s_add_u32 s14, s14, s15
    s_mul_i32 s16, s12, 32768
    s_mul_i32 s15, s3, 4096
    s_add_u32 s16, s16, s15
    s_add_u32 s16, s16, 1998848
    s_add_u32 s17, s16, 2048
    s_mov_b32 s15, 32768
    s_lshl_b32 s22, s12, 10
    s_add_u32 s22, s22, 1933312
    s_branch prep_kernel_pack1
prep_kernel_n7:
    s_cmp_ge_u32 s2, 60
    s_cbranch_scc1 prep_kernel_n8
    s_mov_b32 s8, s28
    s_mov_b32 s9, s29
    s_mov_b32 s10, 16384
    s_mov_b32 s11, 0x20000
    s_mov_b32 s60, s38
    s_mov_b32 s61, s39
    s_mov_b32 s62, 0
    s_mov_b32 s63, 0x20000
    s_sub_u32 s12, s2, 59
    s_mov_b32 s13, 32
    s_mul_i32 s14, s12, 64
    s_mul_i32 s15, s3, 2048
    s_add_u32 s14, s14, s15
    s_mul_i32 s16, s12, 32768
    s_mul_i32 s15, s3, 4096
    s_add_u32 s16, s16, s15
    s_add_u32 s16, s16, 2523136
    s_add_u32 s17, s16, 2048
    s_mov_b32 s15, 1024
    s_lshl_b32 s22, s12, 10
    s_add_u32 s22, s22, 1949696
    s_branch prep_kernel_kv4
prep_kernel_n8:
    s_cmp_lt_u32 s2, 124
    s_cbranch_scc1 prep_kernel_xp2
    s_cmp_ge_u32 s2, 140
    s_cbranch_scc1 prep_kernel_n9
    s_mov_b32 s8, s32
    s_mov_b32 s9, s33
    s_mov_b32 s10, 524288
    s_mov_b32 s11, 0x20000
    s_mov_b32 s60, s38
    s_mov_b32 s61, s39
    s_mov_b32 s62, 0
    s_mov_b32 s63, 0x20000
    s_sub_u32 s12, s2, 124
    s_mov_b32 s13, 1024
    s_mul_i32 s14, s12, 64
    s_mul_i32 s15, s3, 65536
    s_add_u32 s14, s14, s15
    s_mul_i32 s16, s12, 32768
    s_mul_i32 s15, s3, 4096
    s_add_u32 s16, s16, s15
    s_add_u32 s16, s16, 0
    s_add_u32 s17, s16, 2048
    s_mov_b32 s15, 32768
    s_branch prep_kernel_pack1
prep_kernel_n9:
    s_cmp_ge_u32 s2, 183
    s_cbranch_scc1 prep_kernel_n10
    s_mov_b32 s8, s34
    s_mov_b32 s9, s35
    s_mov_b32 s10, 1409024
    s_mov_b32 s11, 0x20000
    s_mov_b32 s60, s38
    s_mov_b32 s61, s39
    s_mov_b32 s62, 0
    s_mov_b32 s63, 0x20000
    s_sub_u32 s12, s2, 140
    s_mov_b32 s13, 1024
    s_mul_i32 s14, s12, 32768
    s_mul_i32 s15, s3, 128
    s_add_u32 s14, s14, s15
    s_mul_i32 s16, s12, 2048
    s_mul_i32 s15, s3, 176128
    s_add_u32 s16, s16, s15
    s_add_u32 s16, s16, 2555904
    s_add_u32 s17, s16, 88064
    s_mov_b32 s15, 64
    s_branch prep_kernel_pack1
prep_kernel_n10:
prep_kernel_end3:
    s_endpgm
prep_kernel_kv4:
    v_and_b32 v6, 7, v2
    v_lshlrev_b32 v6, 2, v6
    v_lshl_add_u32 v6, v5, 5, v6
    s_mul_i32 s40, s13, 0
    s_add_u32 s40, s40, s14
    s_add_u32 s48, s40, s15
    s_mul_i32 s41, s13, 1
    s_add_u32 s41, s41, s14
    s_add_u32 s49, s41, s15
    s_mul_i32 s42, s13, 2
    s_add_u32 s42, s42, s14
    s_add_u32 s50, s42, s15
    s_mul_i32 s43, s13, 3
    s_add_u32 s43, s43, s14
    s_add_u32 s51, s43, s15
    s_mul_i32 s44, s13, 8
    s_add_u32 s44, s44, s14
    s_add_u32 s52, s44, s15
    s_mul_i32 s45, s13, 9
    s_add_u32 s45, s45, s14
    s_add_u32 s53, s45, s15
    s_mul_i32 s46, s13, 10
    s_add_u32 s46, s46, s14
    s_add_u32 s54, s46, s15
    s_mul_i32 s47, s13, 11
    s_add_u32 s47, s47, s14
    s_add_u32 s55, s47, s15
    s_mov_b32 exec_lo, 0x00ff00ff
    s_mov_b32 exec_hi, 0x00ff00ff
    buffer_load_dword v16, v6, s[8:11], s40 offen
    buffer_load_dword v17, v6, s[8:11], s41 offen
    buffer_load_dword v18, v6, s[8:11], s42 offen
    buffer_load_dword v19, v6, s[8:11], s43 offen
    buffer_load_dword v20, v6, s[8:11], s44 offen
    buffer_load_dword v21, v6, s[8:11], s45 offen
    buffer_load_dword v22, v6, s[8:11], s46 offen
    buffer_load_dword v23, v6, s[8:11], s47 offen
    buffer_load_dword v24, v6, s[8:11], s48 offen
    buffer_load_dword v25, v6, s[8:11], s49 offen
    buffer_load_dword v26, v6, s[8:11], s50 offen
    buffer_load_dword v27, v6, s[8:11], s51 offen
    buffer_load_dword v28, v6, s[8:11], s52 offen
    buffer_load_dword v29, v6, s[8:11], s53 offen
    buffer_load_dword v30, v6, s[8:11], s54 offen
    buffer_load_dword v31, v6, s[8:11], s55 offen
    s_not_b64 exec, exec
    s_mov_b32 s8, s30
    s_mov_b32 s9, s31
    buffer_load_dword v16, v6, s[8:11], s40 offen
    buffer_load_dword v17, v6, s[8:11], s41 offen
    buffer_load_dword v18, v6, s[8:11], s42 offen
    buffer_load_dword v19, v6, s[8:11], s43 offen
    buffer_load_dword v20, v6, s[8:11], s44 offen
    buffer_load_dword v21, v6, s[8:11], s45 offen
    buffer_load_dword v22, v6, s[8:11], s46 offen
    buffer_load_dword v23, v6, s[8:11], s47 offen
    buffer_load_dword v24, v6, s[8:11], s48 offen
    buffer_load_dword v25, v6, s[8:11], s49 offen
    buffer_load_dword v26, v6, s[8:11], s50 offen
    buffer_load_dword v27, v6, s[8:11], s51 offen
    buffer_load_dword v28, v6, s[8:11], s52 offen
    buffer_load_dword v29, v6, s[8:11], s53 offen
    buffer_load_dword v30, v6, s[8:11], s54 offen
    buffer_load_dword v31, v6, s[8:11], s55 offen
    s_mov_b64 exec, -1
    s_branch prep_kernel_tr5
prep_kernel_pack1:
    v_mul_lo_u32 v6, v5, s13
    v_lshl_add_u32 v6, v2, 2, v6
    s_mul_i32 s40, s13, 0
    s_add_u32 s40, s40, s14
    s_add_u32 s48, s40, s15
    s_mul_i32 s41, s13, 1
    s_add_u32 s41, s41, s14
    s_add_u32 s49, s41, s15
    s_mul_i32 s42, s13, 2
    s_add_u32 s42, s42, s14
    s_add_u32 s50, s42, s15
    s_mul_i32 s43, s13, 3
    s_add_u32 s43, s43, s14
    s_add_u32 s51, s43, s15
    s_mul_i32 s44, s13, 8
    s_add_u32 s44, s44, s14
    s_add_u32 s52, s44, s15
    s_mul_i32 s45, s13, 9
    s_add_u32 s45, s45, s14
    s_add_u32 s53, s45, s15
    s_mul_i32 s46, s13, 10
    s_add_u32 s46, s46, s14
    s_add_u32 s54, s46, s15
    s_mul_i32 s47, s13, 11
    s_add_u32 s47, s47, s14
    s_add_u32 s55, s47, s15
    buffer_load_dword v16, v6, s[8:11], s40 offen
    buffer_load_dword v17, v6, s[8:11], s41 offen
    buffer_load_dword v18, v6, s[8:11], s42 offen
    buffer_load_dword v19, v6, s[8:11], s43 offen
    buffer_load_dword v20, v6, s[8:11], s44 offen
    buffer_load_dword v21, v6, s[8:11], s45 offen
    buffer_load_dword v22, v6, s[8:11], s46 offen
    buffer_load_dword v23, v6, s[8:11], s47 offen
    buffer_load_dword v24, v6, s[8:11], s48 offen
    buffer_load_dword v25, v6, s[8:11], s49 offen
    buffer_load_dword v26, v6, s[8:11], s50 offen
    buffer_load_dword v27, v6, s[8:11], s51 offen
    buffer_load_dword v28, v6, s[8:11], s52 offen
    buffer_load_dword v29, v6, s[8:11], s53 offen
    buffer_load_dword v30, v6, s[8:11], s54 offen
    buffer_load_dword v31, v6, s[8:11], s55 offen
prep_kernel_tr5:
    v_mov_b32 v8, 0
    v_mov_b32 v9, 0
    s_waitcnt vmcnt(8)
    v_perm_b32 v32, v17, v16, s18
    v_perm_b32 v33, v19, v18, s18
    v_perm_b32 v34, v21, v20, s18
    v_perm_b32 v35, v23, v22, s18
    buffer_store_dwordx4 v[32:35], v7, s[4:7], s16 offen offset:0
    v_perm_b32 v36, v17, v16, s19
    v_perm_b32 v37, v19, v18, s19
    v_perm_b32 v38, v21, v20, s19
    v_perm_b32 v39, v23, v22, s19
    buffer_store_dwordx4 v[36:39], v7, s[4:7], s16 offen offset:16
    s_waitcnt vmcnt(2)
    v_perm_b32 v40, v25, v24, s18
    v_perm_b32 v41, v27, v26, s18
    v_perm_b32 v42, v29, v28, s18
    v_perm_b32 v43, v31, v30, s18
    buffer_store_dwordx4 v[40:43], v7, s[4:7], s17 offen offset:0
    v_perm_b32 v44, v25, v24, s19
    v_perm_b32 v45, v27, v26, s19
    v_perm_b32 v46, v29, v28, s19
    v_perm_b32 v47, v31, v30, s19
    buffer_store_dwordx4 v[44:47], v7, s[4:7], s17 offen offset:16
    s_cmp_eq_u32 s22, 0
    s_cbranch_scc1 prep_kernel_end3
    v_dot2c_f32_bf16 v8, s23, v32
    v_dot2c_f32_bf16 v9, s23, v36
    v_dot2c_f32_bf16 v8, s23, v33
    v_dot2c_f32_bf16 v9, s23, v37
    v_dot2c_f32_bf16 v8, s23, v34
    v_dot2c_f32_bf16 v9, s23, v38
    v_dot2c_f32_bf16 v8, s23, v35
    v_dot2c_f32_bf16 v9, s23, v39
    v_dot2c_f32_bf16 v8, s23, v40
    v_dot2c_f32_bf16 v9, s23, v44
    v_dot2c_f32_bf16 v8, s23, v41
    v_dot2c_f32_bf16 v9, s23, v45
    v_dot2c_f32_bf16 v8, s23, v42
    v_dot2c_f32_bf16 v9, s23, v46
    v_dot2c_f32_bf16 v8, s23, v43
    v_dot2c_f32_bf16 v9, s23, v47
    v_lshlrev_b32 v10, 3, v0
    v_and_b32 v11, 31, v0
    s_lshl_b32 s14, s12, 6
    v_lshlrev_b32 v12, 1, v11
    ds_write_b64 v10, v[8:9]
    buffer_load_ushort v50, v12, s[60:63], s14 offen
    v_lshlrev_b32 v10, 11, v4
    v_lshl_add_u32 v10, v11, 2, v10
    s_waitcnt lgkmcnt(0)
    s_barrier
    s_cmp_lg_u32 s3, 0
    s_cbranch_scc1 prep_kernel_end3
    ds_read_b32 v16, v10 offset:0
    ds_read_b32 v17, v10 offset:128
    ds_read_b32 v18, v10 offset:256
    ds_read_b32 v19, v10 offset:384
    ds_read_b32 v20, v10 offset:512
    ds_read_b32 v21, v10 offset:640
    ds_read_b32 v22, v10 offset:768
    ds_read_b32 v23, v10 offset:896
    ds_read_b32 v24, v10 offset:1024
    ds_read_b32 v25, v10 offset:1152
    ds_read_b32 v26, v10 offset:1280
    ds_read_b32 v27, v10 offset:1408
    ds_read_b32 v28, v10 offset:1536
    ds_read_b32 v29, v10 offset:1664
    ds_read_b32 v30, v10 offset:1792
    ds_read_b32 v31, v10 offset:1920
    v_lshlrev_b32 v3, 4, v0
    v_cmp_eq_u32 vcc, 0, v4
    s_waitcnt lgkmcnt(0)
    v_add_f32 v16, v16, v24
    v_add_f32 v17, v17, v25
    v_add_f32 v18, v18, v26
    v_add_f32 v19, v19, v27
    v_add_f32 v20, v20, v28
    v_add_f32 v21, v21, v29
    v_add_f32 v22, v22, v30
    v_add_f32 v23, v23, v31
    v_add_f32 v16, v16, v20
    v_add_f32 v17, v17, v21
    v_add_f32 v18, v18, v22
    v_add_f32 v19, v19, v23
    v_add_f32 v16, v16, v18
    v_add_f32 v17, v17, v19
    v_add_f32 v16, v16, v17
    v_mov_b32 v17, v16
    s_nop 1
    v_permlane32_swap_b32 v16, v17
    s_nop 1
    v_add_f32 v16, v16, v17
    v_cvt_pk_bf16_f32 v48, v16, v16
    v_and_b32 v49, 0xffff0000, v48
    v_sub_f32 v49, v16, v49
    v_cvt_pk_bf16_f32 v49, v49, v49
    v_mov_b32 v51, 0
    s_waitcnt vmcnt(0)
    v_lshl_or_b32 v50, v50, 16, v50
    v_cndmask_b32 v48, 0, v48, vcc
    v_cndmask_b32 v49, 0, v49, vcc
    v_cndmask_b32 v50, 0, v50, vcc
    buffer_store_dwordx4 v[48:51], v3, s[4:7], s22 offen
    s_endpgm
prep_kernel_xp2:
    s_mov_b32 s8, s24
    s_mov_b32 s9, s25
    s_mov_b32 s10, 2097152
    s_mov_b32 s11, 0x20000
    s_sub_u32 s13, s2, 60
    s_lshr_b32 s13, s13, 3
    s_and_b32 s14, s2, 7
    s_lshl_b32 s14, s14, 3
    s_add_u32 s13, s13, s14
    s_lshr_b32 s14, s3, 2
    v_and_b32 v1, 7, v0
    s_and_b32 s15, s3, 3
    s_lshl_b32 s15, s15, 3
    v_add_u32 v1, s15, v1
    v_bfe_u32 v2, v0, 3, 3
    v_lshlrev_b32 v3, 10, v1
    v_lshl_add_u32 v3, v2, 5, v3
    s_lshl_b32 s16, s13, 15
    s_lshl_b32 s17, s14, 9
    s_add_u32 s16, s16, s17
    buffer_load_dwordx4 v[16:19], v3, s[8:11], s16 offen
    buffer_load_dwordx4 v[20:23], v3, s[8:11], s16 offen offset:16
    buffer_load_dwordx4 v[24:27], v3, s[8:11], s16 offen offset:256
    buffer_load_dwordx4 v[28:31], v3, s[8:11], s16 offen offset:272
    v_lshlrev_b32 v4, 10, v2
    v_lshl_add_u32 v4, v1, 4, v4
    s_lshl_b32 s17, s13, 15
    s_lshl_b32 s18, s14, 14
    s_add_u32 s17, s17, s18
    s_add_u32 s17, s17, 3973120
    s_add_u32 s18, s17, 8192
    v_mov_b32 v32, 0
    v_mov_b32 v33, 0
    v_lshrrev_b32 v5, 1, v2
    v_lshlrev_b32 v5, 10, v5
    v_lshl_add_u32 v5, v1, 4, v5
    v_and_b32 v6, 1, v2
    v_lshl_add_u32 v5, v6, 3, v5
    s_lshl_b32 s15, s13, 12
    s_lshl_b32 s16, s14, 9
    s_add_u32 s15, s15, s16
    s_add_u32 s15, s15, 8167424
    v_mov_b32 v36, -1
    v_mov_b32 v37, -1
    v_mov_b32 v38, -1
    v_mov_b32 v39, -1
    v_lshlrev_b32 v7, 4, v0
    v_and_b32 v8, 0x70, v7
    v_bfe_u32 v9, v0, 5, 1
    v_lshl_add_u32 v8, v9, 19, v8
    v_lshlrev_b32 v9, 19, v9
    v_and_b32 v10, 15, v0
    v_lshl_add_u32 v9, v10, 7, v9
    v_bfe_u32 v10, v0, 4, 1
    v_lshl_add_u32 v9, v10, 17, v9
    s_lshl_b32 s45, s13, 11
    s_add_u32 s45, s45, 8691712
    s_lshl_b32 s40, s13, 15
    s_add_u32 s40, s40, 10985472
    s_add_u32 s41, s40, 8192
    s_add_u32 s42, s40, 16384
    s_add_u32 s43, s40, 24576
    s_lshl_b32 s44, s13, 7
    s_add_u32 s44, s44, 8953856
    s_cmp_lg_u32 s3, 0
    s_cselect_b32 s44, 0x7ff00000, s44
    s_cselect_b32 s45, 0x7ff00000, s45
    buffer_store_dwordx4 v[36:39], v7, s[4:7], s40 offen sc1
    buffer_store_dwordx4 v[36:39], v7, s[4:7], s41 offen sc1
    buffer_store_dwordx4 v[36:39], v7, s[4:7], s42 offen sc1
    buffer_store_dwordx4 v[36:39], v7, s[4:7], s43 offen sc1
    buffer_store_dwordx4 v[36:39], v8, s[4:7], s44 offen sc1
    buffer_store_dword v36, v9, s[4:7], s45 offen sc1
    s_waitcnt vmcnt(8)
    v_swap_b32 v18, v20
    v_swap_b32 v19, v21
    buffer_store_dwordx4 v[16:19], v4, s[4:7], s17 offen
    buffer_store_dwordx4 v[20:23], v4, s[4:7], s17 offen offset:512
    s_waitcnt vmcnt(8)
    v_swap_b32 v26, v28
    v_swap_b32 v27, v29
    buffer_store_dwordx4 v[24:27], v4, s[4:7], s18 offen
    buffer_store_dwordx4 v[28:31], v4, s[4:7], s18 offen offset:512
    v_dot2c_f32_bf16 v32, s23, v16
    v_dot2c_f32_bf16 v33, v16, v16
    v_dot2c_f32_bf16 v32, s23, v17
    v_dot2c_f32_bf16 v33, v17, v17
    v_dot2c_f32_bf16 v32, s23, v18
    v_dot2c_f32_bf16 v33, v18, v18
    v_dot2c_f32_bf16 v32, s23, v19
    v_dot2c_f32_bf16 v33, v19, v19
    v_dot2c_f32_bf16 v32, s23, v20
    v_dot2c_f32_bf16 v33, v20, v20
    v_dot2c_f32_bf16 v32, s23, v21
    v_dot2c_f32_bf16 v33, v21, v21
    v_dot2c_f32_bf16 v32, s23, v22
    v_dot2c_f32_bf16 v33, v22, v22
    v_dot2c_f32_bf16 v32, s23, v23
    v_dot2c_f32_bf16 v33, v23, v23
    v_dot2c_f32_bf16 v32, s23, v24
    v_dot2c_f32_bf16 v33, v24, v24
    v_dot2c_f32_bf16 v32, s23, v25
    v_dot2c_f32_bf16 v33, v25, v25
    v_dot2c_f32_bf16 v32, s23, v26
    v_dot2c_f32_bf16 v33, v26, v26
    v_dot2c_f32_bf16 v32, s23, v27
    v_dot2c_f32_bf16 v33, v27, v27
    v_dot2c_f32_bf16 v32, s23, v28
    v_dot2c_f32_bf16 v33, v28, v28
    v_dot2c_f32_bf16 v32, s23, v29
    v_dot2c_f32_bf16 v33, v29, v29
    v_dot2c_f32_bf16 v32, s23, v30
    v_dot2c_f32_bf16 v33, v30, v30
    v_dot2c_f32_bf16 v32, s23, v31
    v_dot2c_f32_bf16 v33, v31, v31
    s_nop 3
    buffer_store_dwordx2 v[32:33], v5, s[4:7], s15 offen
    s_endpgm
.globl layer2_kernel
.p2align 8
.type layer2_kernel,@function
layer2_kernel:
    s_mov_b32 s59, 524288
    s_branch attn_kernel_main
.globl attn_kernel
.p2align 8
.type attn_kernel,@function
attn_kernel:
    s_mov_b32 s59, 0
attn_kernel_main:
    s_cmp_ge_u32 s2, 256
    s_cbranch_scc1 attn_kernel_end
    s_load_dwordx2 s[20:21], s[0:1], 96
    v_lshrrev_b32 v2, 6, v0
    v_and_b32 v3, 63, v0
    v_readfirstlane_b32 s3, v2
    v_lshlrev_b32 v1, 4, v3
    v_lshlrev_b32 v2, 2, v3
    s_and_b32 s16, s2, 7
    s_lshl_b32 s16, s16, 3
    s_lshr_b32 s17, s2, 5
    s_add_u32 s16, s16, s17
    s_bfe_u32 s17, s2, 0x20003
    s_mov_b32 s54, s17
    s_lshl_b32 s38, s17, 2
    s_and_b32 s39, s3, 3
    s_add_u32 s38, s38, s39
    s_lshr_b32 s39, s3, 2
    s_lshl_b32 s52, s38, 15
    s_lshl_b32 s44, s39, 12
    s_add_u32 s52, s52, s44
    s_add_u32 s52, s52, 0
    s_lshl_b32 s53, s17, 13
    s_add_u32 s43, s52, s53
    s_and_b32 s18, s3, 1
    s_lshr_b32 s19, s3, 1
    s_lshl_b32 s22, s16, 5
    s_lshl_b32 s17, s17, 3
    s_add_u32 s22, s22, s17
    s_lshl_b32 s17, s18, 2
    s_add_u32 s22, s22, s17
    s_waitcnt lgkmcnt(0)
    s_setprio 1
    s_cmp_lt_u32 s3, 4
    s_cbranch_scc1 attn_kernel_p
    s_setprio 2
attn_kernel_p:
    s_mov_b32 s4, s20
    s_mov_b32 s5, s21
    s_mov_b32 s6, 18718720
    s_mov_b32 s7, 0x20000
    s_mov_b32 s8, s20
    s_mov_b32 s9, s21
    s_mov_b32 s10, 1998848
    s_mov_b32 s11, 0x20000
    s_lshr_b32 s42, s2, 3
    s_lshl_b32 s42, s42, 3
    s_add_u32 s42, s42, s3
    s_lshl_b32 s42, s42, 10
    s_add_u32 s42, s42, 524288
    s_add_u32 s24, s22, s19
    s_lshl_b32 s24, s24, 10
    s_add_u32 s24, s24, 8691712
    s_lshl_b32 s56, s3, 12
    s_lshl_b32 s26, s16, 15
    s_add_u32 s26, s26, s56
    s_add_u32 s26, s26, 3973120
    s_and_b32 s27, s3, 3
    s_lshl_b32 s27, s27, 10
    s_lshl_b32 s28, s16, 12
    s_add_u32 s28, s28, s27
    s_mov_b32 m0, s27
    s_add_u32 s28, s28, 8167424
    s_cmp_ge_u32 s3, 4
    s_cbranch_scc1 attn_kernel_ns
    buffer_load_dwordx4 v1, s[4:7], s28 offen lds
attn_kernel_ns:
    buffer_load_dwordx4 v[96:99], v1, s[4:7], s26 offen offset:0
    buffer_load_dwordx4 v[100:103], v1, s[4:7], s26 offen offset:1024
    buffer_load_dwordx4 v[104:107], v1, s[4:7], s26 offen offset:2048
    buffer_load_dwordx4 v[108:111], v1, s[4:7], s26 offen offset:3072
    v_and_b32 v4, 31, v3
    s_lshl_b32 s27, s54, 8
    v_add_u32 v5, s27, v1
    v_mov_b32 v6, 0x7ff00000
    v_cmp_gt_u32 vcc, 16, v4
    s_add_u32 s27, s56, 2523136
    s_cmp_ge_u32 s54, 2
    s_cselect_b32 s27, 0x7ff00000, s27
    v_cndmask_b32 v5, v6, v5, vcc
    s_cmp_lt_u32 s3, 2
    s_mov_b32 s28, 0x7ff00000
    s_cselect_b32 s28, 1949696, s28
    s_lshl_b32 s29, s38, 10
    s_add_u32 s29, s29, 1933312
    s_cmp_lg_u32 s39, 0
    s_cselect_b32 s29, 0x7ff00000, s29
    s_lshl_b32 s55, s38, 15
    s_lshl_b32 s30, s39, 14
    s_add_u32 s55, s55, s30
    s_add_u32 s55, s55, 1998848
    buffer_load_dwordx4 v[112:115], v5, s[4:7], s27 offen offset:0
    buffer_load_dwordx4 v[116:119], v5, s[4:7], s27 offen offset:1024
    buffer_load_dwordx4 v[120:123], v5, s[4:7], s27 offen offset:2048
    buffer_load_dwordx4 v[124:127], v5, s[4:7], s27 offen offset:3072
    buffer_load_dwordx4 v[88:91], v5, s[4:7], s28 offen
    buffer_load_dwordx4 v[84:87], v1, s[4:7], s29 offen
    s_add_u32 s30, s56, 55296
    v_add_u32 v6, s30, v1
    v_add_u32 v7, s56, v1
    s_cmp_lt_u32 s54, 2
    s_cselect_b32 s57, s54, -1
    s_cselect_b32 s58, s54, 7
    s_add_u32 s57, s57, 1
    s_barrier
    s_cmp_gt_u32 s3, s58
    s_cbranch_scc1 attn_kernel_nw
    buffer_load_dwordx4 a[0:3], v1, s[4:7], s55 offen offset:0
    buffer_load_dwordx4 a[4:7], v1, s[4:7], s55 offen offset:1024
    buffer_load_dwordx4 a[8:11], v1, s[4:7], s55 offen offset:2048
    buffer_load_dwordx4 a[12:15], v1, s[4:7], s55 offen offset:3072
    s_add_u32 s55, s55, 4096
    buffer_load_dwordx4 a[16:19], v1, s[4:7], s55 offen offset:0
    buffer_load_dwordx4 a[20:23], v1, s[4:7], s55 offen offset:1024
    buffer_load_dwordx4 a[24:27], v1, s[4:7], s55 offen offset:2048
    buffer_load_dwordx4 a[28:31], v1, s[4:7], s55 offen offset:3072
    s_add_u32 s55, s55, 4096
    buffer_load_dwordx4 a[32:35], v1, s[4:7], s55 offen offset:0
    buffer_load_dwordx4 a[36:39], v1, s[4:7], s55 offen offset:1024
    buffer_load_dwordx4 a[40:43], v1, s[4:7], s55 offen offset:2048
    buffer_load_dwordx4 a[44:47], v1, s[4:7], s55 offen offset:3072
    s_add_u32 s55, s55, 4096
    buffer_load_dwordx4 a[48:51], v1, s[4:7], s55 offen offset:0
    buffer_load_dwordx4 a[52:55], v1, s[4:7], s55 offen offset:1024
    buffer_load_dwordx4 a[56:59], v1, s[4:7], s55 offen offset:2048
    buffer_load_dwordx4 a[60:63], v1, s[4:7], s55 offen offset:3072
    s_add_u32 s55, s55, 4096
    s_waitcnt vmcnt(16)
    s_branch attn_kernel_nw2
attn_kernel_nw:
    s_waitcnt vmcnt(0)
attn_kernel_nw2:
    ds_write_b128 v6, v[96:99] offset:0
    ds_write_b128 v6, v[100:103] offset:1024
    ds_write_b128 v6, v[104:107] offset:2048
    ds_write_b128 v6, v[108:111] offset:3072
    s_cmp_ge_u32 s54, 2
    s_cbranch_scc1 attn_kernel_k2
    s_cmp_eq_u32 s54, 0
    s_cbranch_scc1 attn_kernel_k1
    v_mfma_f32_32x32x16_bf16 v[32:47], v[96:99], v[112:115], 0
    v_mfma_f32_32x32x16_bf16 v[32:47], v[100:103], v[116:119], v[32:47]
    v_mfma_f32_32x32x16_bf16 v[32:47], v[104:107], v[120:123], v[32:47]
    v_mfma_f32_32x32x16_bf16 v[32:47], v[108:111], v[124:127], v[32:47]
    s_nop 15
    s_nop 1
    ds_write_b128 v7, v[40:43] offset:6144
    ds_write_b128 v7, v[44:47] offset:7168
    s_branch attn_kernel_k4
attn_kernel_k1:
    v_mfma_f32_32x32x16_bf16 v[32:47], v[112:115], v[96:99], 0
    v_mfma_f32_32x32x16_bf16 v[32:47], v[116:119], v[100:103], v[32:47]
    v_mfma_f32_32x32x16_bf16 v[32:47], v[120:123], v[104:107], v[32:47]
    v_mfma_f32_32x32x16_bf16 v[32:47], v[124:127], v[108:111], v[32:47]
    s_nop 15
    s_nop 1
attn_kernel_k4:
    ds_write_b128 v7, v[32:35] offset:4096
    ds_write_b128 v7, v[36:39] offset:5120
attn_kernel_k2:
    s_lshl_b32 s30, s3, 11
    v_add_u32 v14, s30, v1
    s_xor_b32 s30, s3, 1
    s_lshl_b32 s30, s30, 12
    v_add_u32 v15, s30, v14
    s_waitcnt lgkmcnt(0)
    s_barrier
    ds_read_b128 v[64:67], v1 offset:0
    ds_read_b128 v[68:71], v1 offset:1024
    ds_read_b128 v[72:75], v1 offset:2048
    ds_read_b128 v[76:79], v1 offset:3072
    s_cmp_ge_u32 s3, s57
    s_cbranch_scc1 attn_kernel_k8
    s_setprio 3
    ds_read_b128 v[96:99], v15 offset:4096
    ds_read_b128 v[100:103], v15 offset:5120
    ds_read_b128 v[104:107], v14 offset:12288
    ds_read_b128 v[108:111], v14 offset:13312
    ds_read_b128 v[112:115], v14 offset:16384
    ds_read_b128 v[116:119], v14 offset:17408
    ds_read_b128 v[120:123], v14 offset:20480
    ds_read_b128 v[124:127], v14 offset:21504
    ds_read_b128 v[128:131], v14 offset:24576
    ds_read_b128 v[132:135], v14 offset:25600
    ds_read_b128 v[136:139], v14 offset:28672
    ds_read_b128 v[140:143], v14 offset:29696
    ds_read_b128 v[144:147], v14 offset:32768
    ds_read_b128 v[148:151], v14 offset:33792
    s_waitcnt lgkmcnt(14)
    s_branch attn_kernel_k9
attn_kernel_k8:
    s_cmp_le_u32 s3, s58
    s_cbranch_scc1 attn_kernel_kb
    buffer_load_dwordx4 a[0:3], v1, s[4:7], s55 offen offset:0
    buffer_load_dwordx4 a[4:7], v1, s[4:7], s55 offen offset:1024
    buffer_load_dwordx4 a[8:11], v1, s[4:7], s55 offen offset:2048
    buffer_load_dwordx4 a[12:15], v1, s[4:7], s55 offen offset:3072
    s_add_u32 s55, s55, 4096
    buffer_load_dwordx4 a[16:19], v1, s[4:7], s55 offen offset:0
    buffer_load_dwordx4 a[20:23], v1, s[4:7], s55 offen offset:1024
    buffer_load_dwordx4 a[24:27], v1, s[4:7], s55 offen offset:2048
    buffer_load_dwordx4 a[28:31], v1, s[4:7], s55 offen offset:3072
    s_add_u32 s55, s55, 4096
    buffer_load_dwordx4 a[32:35], v1, s[4:7], s55 offen offset:0
    buffer_load_dwordx4 a[36:39], v1, s[4:7], s55 offen offset:1024
    buffer_load_dwordx4 a[40:43], v1, s[4:7], s55 offen offset:2048
    buffer_load_dwordx4 a[44:47], v1, s[4:7], s55 offen offset:3072
    s_add_u32 s55, s55, 4096
    buffer_load_dwordx4 a[48:51], v1, s[4:7], s55 offen offset:0
    buffer_load_dwordx4 a[52:55], v1, s[4:7], s55 offen offset:1024
    buffer_load_dwordx4 a[56:59], v1, s[4:7], s55 offen offset:2048
    buffer_load_dwordx4 a[60:63], v1, s[4:7], s55 offen offset:3072
    s_add_u32 s55, s55, 4096
attn_kernel_kb:
    s_waitcnt lgkmcnt(0)
attn_kernel_k9:
    v_cmp_gt_u32 vcc, 32, v3
    v_mov_b32 v92, 0
    v_mov_b32 v93, 0
    v_mov_b32 v94, 0
    v_mov_b32 v95, 0x3f803f80
    v_cndmask_b32 v95, 0, v95, vcc
    v_add_f32 v64, v64, v72
    v_add_f32 v65, v65, v73
    v_add_f32 v66, v66, v74
    v_add_f32 v67, v67, v75
    v_add_f32 v68, v68, v76
    v_add_f32 v69, v69, v77
    v_add_f32 v70, v70, v78
    v_add_f32 v71, v71, v79
    v_add_f32 v64, v64, v68
    v_add_f32 v65, v65, v69
    v_add_f32 v66, v66, v70
    v_add_f32 v67, v67, v71
    v_add_f32 v64, v64, v66
    v_add_f32 v65, v65, v67
    s_nop 1
    v_permlane32_swap_b32 v64, v65
    s_nop 1
    v_add_f32 v12, v64, v65
    v_add_f32 v13, v64, v65
    s_nop 1
    v_permlane32_swap_b32 v12, v13
    s_nop 1
    v_mul_f32 v10, 0x3b000000, v12
    v_mul_f32 v13, 0x3b000000, v13
    v_fma_f32 v13, -v10, v10, v13
    v_max_f32 v13, 0, v13
    v_add_f32 v13, 0x3727c5ac, v13
    v_rsq_f32 v11, v13
    s_nop 0
    v_mul_f32 v12, v13, v11
    v_cvt_pk_bf16_f32 v8, -v10, -v10
    v_cvt_pk_bf16_f32 v9, v12, v12
    v_cvt_pk_bf16_f32 v13, v11, v11
    v_and_b32 v8, 0xffff0000, v8
    v_and_b32 v9, 0xffff0000, v9
    v_and_b32 v13, 0xffff0000, v13
    v_sub_f32_e64 v8, -v10, v8
    v_sub_f32 v9, v12, v9
    v_sub_f32 v13, v11, v13
    v_cvt_pk_bf16_f32 v80, -v10, v8
    v_cvt_pk_bf16_f32 v81, -v10, v8
    v_cvt_pk_bf16_f32 v82, v12, v9
    v_cvt_pk_bf16_f32 v83, v11, v13
    s_cmp_ge_u32 s3, s57
    s_cbranch_scc1 attn_kernel_q
    s_lshl_b32 s30, s16, 7
    s_add_u32 s30, s30, 8953856
    s_add_u32 s30, s30, s59
    s_cmp_eq_u32 s54, 0
    s_cbranch_scc1 attn_kernel_k3
    v_mfma_f32_32x32x16_bf16 v[32:47], v[80:83], v[88:91], v[32:47]
    v_mfma_f32_32x32x16_bf16 v[48:63], v[80:83], v[92:95], 0
    s_branch attn_kernel_k7
attn_kernel_k3:
    v_mfma_f32_32x32x16_bf16 v[32:47], v[88:91], v[80:83], v[32:47]
attn_kernel_k7:
    v_and_b32 v9, 27, v4
    v_cmp_eq_u32 vcc, 16, v9
    v_mov_b32 v9, 0x3f803f80
    s_nop 1
    v_cndmask_b32 v9, 0, v9, vcc
    s_waitcnt lgkmcnt(10)
    v_add_f32 v96, v96, v104
    v_add_f32 v97, v97, v105
    v_add_f32 v98, v98, v106
    v_add_f32 v99, v99, v107
    v_add_f32 v100, v100, v108
    v_add_f32 v101, v101, v109
    v_add_f32 v102, v102, v110
    v_add_f32 v103, v103, v111
    s_waitcnt lgkmcnt(8)
    v_add_f32 v96, v96, v112
    v_add_f32 v97, v97, v113
    v_add_f32 v98, v98, v114
    v_add_f32 v99, v99, v115
    v_add_f32 v100, v100, v116
    v_add_f32 v101, v101, v117
    v_add_f32 v102, v102, v118
    v_add_f32 v103, v103, v119
    s_waitcnt lgkmcnt(6)
    v_add_f32 v96, v96, v120
    v_add_f32 v97, v97, v121
    v_add_f32 v98, v98, v122
    v_add_f32 v99, v99, v123
    v_add_f32 v100, v100, v124
    v_add_f32 v101, v101, v125
    v_add_f32 v102, v102, v126
    v_add_f32 v103, v103, v127
    s_waitcnt lgkmcnt(4)
    v_add_f32 v96, v96, v128
    v_add_f32 v97, v97, v129
    v_add_f32 v98, v98, v130
    v_add_f32 v99, v99, v131
    v_add_f32 v100, v100, v132
    v_add_f32 v101, v101, v133
    v_add_f32 v102, v102, v134
    v_add_f32 v103, v103, v135
    s_waitcnt lgkmcnt(2)
    v_add_f32 v96, v96, v136
    v_add_f32 v97, v97, v137
    v_add_f32 v98, v98, v138
    v_add_f32 v99, v99, v139
    v_add_f32 v100, v100, v140
    v_add_f32 v101, v101, v141
    v_add_f32 v102, v102, v142
    v_add_f32 v103, v103, v143
    s_waitcnt lgkmcnt(0)
    v_add_f32 v96, v96, v144
    v_add_f32 v97, v97, v145
    v_add_f32 v98, v98, v146
    v_add_f32 v99, v99, v147
    v_add_f32 v100, v100, v148
    v_add_f32 v101, v101, v149
    v_add_f32 v102, v102, v150
    v_add_f32 v103, v103, v151
    s_cmp_eq_u32 s54, 0
    s_cbranch_scc1 attn_kernel_k5
    s_cmp_eq_u32 s3, 0
    s_cbranch_scc1 attn_kernel_ka
    v_mov_b32 v32, v40
    v_mov_b32 v48, v56
    v_mov_b32 v33, v41
    v_mov_b32 v49, v57
    v_mov_b32 v34, v42
    v_mov_b32 v50, v58
    v_mov_b32 v35, v43
    v_mov_b32 v51, v59
    v_mov_b32 v36, v44
    v_mov_b32 v52, v60
    v_mov_b32 v37, v45
    v_mov_b32 v53, v61
    v_mov_b32 v38, v46
    v_mov_b32 v54, v62
    v_mov_b32 v39, v47
    v_mov_b32 v55, v63
attn_kernel_ka:
    v_add_f32 v96, v96, v32
    v_add_f32 v97, v97, v33
    v_add_f32 v98, v98, v34
    v_add_f32 v99, v99, v35
    v_add_f32 v100, v100, v36
    v_add_f32 v101, v101, v37
    v_add_f32 v102, v102, v38
    v_add_f32 v103, v103, v39
    v_mul_f32 v96, v96, v48
    v_mul_f32 v97, v97, v49
    v_mul_f32 v98, v98, v50
    v_mul_f32 v99, v99, v51
    v_mul_f32 v100, v100, v52
    v_mul_f32 v101, v101, v53
    v_mul_f32 v102, v102, v54
    v_mul_f32 v103, v103, v55
    v_cvt_pk_bf16_f32 v104, v96, v97
    v_cvt_pk_bf16_f32 v105, v98, v99
    v_cvt_pk_bf16_f32 v106, v100, v101
    v_cvt_pk_bf16_f32 v107, v102, v103
    v_or_b32 v104, v104, v9
    v_or_b32 v105, v105, v9
    v_or_b32 v106, v106, v9
    v_or_b32 v107, v107, v9
    s_lshl_b32 s31, s16, 1
    s_add_u32 s31, s31, s3
    s_lshl_b32 s31, s31, 10
    s_add_u32 s31, s31, 10854400
    buffer_store_dwordx4 v[104:107], v1, s[4:7], s31 offen sc1
    s_lshl_b32 s31, s3, 2
    s_add_u32 s30, s30, s31
    s_add_u32 s30, s30, 4
    s_mov_b32 s32, 0
    s_branch attn_kernel_k6
attn_kernel_k5:
    v_add_f32 v96, v96, v32
    v_add_f32 v97, v97, v33
    v_add_f32 v98, v98, v34
    v_add_f32 v99, v99, v35
    v_add_f32 v100, v100, v36
    v_add_f32 v101, v101, v37
    v_add_f32 v102, v102, v38
    v_add_f32 v103, v103, v39
    v_mul_f32 v96, v96, v11
    v_mul_f32 v97, v97, v11
    v_mul_f32 v98, v98, v11
    v_mul_f32 v99, v99, v11
    v_mul_f32 v100, v100, v11
    v_mul_f32 v101, v101, v11
    v_mul_f32 v102, v102, v11
    v_mul_f32 v103, v103, v11
    v_cvt_pk_bf16_f32 v104, v96, v97
    v_cvt_pk_bf16_f32 v105, v98, v99
    v_cvt_pk_bf16_f32 v106, v100, v101
    v_cvt_pk_bf16_f32 v107, v102, v103
    s_lshl_b32 s31, s16, 10
    s_add_u32 s31, s31, 10788864
    buffer_store_dwordx4 v[104:107], v1, s[4:7], s31 offen sc1
    v_mul_f32 v12, v96, v96
    v_fma_f32 v12, v97, v97, v12
    v_fma_f32 v12, v98, v98, v12
    v_fma_f32 v12, v99, v99, v12
    v_fma_f32 v12, v100, v100, v12
    v_fma_f32 v12, v101, v101, v12
    v_fma_f32 v12, v102, v102, v12
    v_fma_f32 v12, v103, v103, v12
    v_mov_b32 v13, v12
    s_nop 1
    v_permlane32_swap_b32 v12, v13
    s_nop 1
    v_add_f32 v12, v12, v13
    s_nop 1
    v_max_f32_dpp v12, v12, v12 quad_perm:[1,0,3,2] row_mask:0xf bank_mask:0xf
    s_nop 1
    v_max_f32_dpp v12, v12, v12 quad_perm:[2,3,0,1] row_mask:0xf bank_mask:0xf
    s_nop 1
    v_max_f32_dpp v12, v12, v12 row_half_mirror row_mask:0xf bank_mask:0xf
    s_nop 1
    v_max_f32_dpp v12, v12, v12 row_mirror row_mask:0xf bank_mask:0xf
    s_nop 1
    v_readlane_b32 s32, v12, 0
    v_readlane_b32 s33, v12, 16
    s_max_u32 s32, s32, s33
    s_min_u32 s32, s32, -2
attn_kernel_k6:
    v_mov_b32 v13, s32
    v_mov_b32 v9, 0
    s_mov_b64 exec, 1
    s_waitcnt vmcnt(0)
    buffer_store_dword v13, v9, s[4:7], s30 offen sc1
    s_mov_b64 exec, -1
    s_setprio 1
attn_kernel_q:
    s_lshl_b32 s30, s39, 14
    s_add_u32 s30, s30, 55296
    v_add_u32 v6, s30, v1
    v_lshlrev_b32 v5, 7, v3
    s_add_u32 s28, s59, 8953856
    s_mov_b32 s34, 0x1000
    ds_read_b128 v[96:99], v6 offset:0
    ds_read_b128 v[100:103], v6 offset:1024
    ds_read_b128 v[104:107], v6 offset:2048
    ds_read_b128 v[108:111], v6 offset:3072
    ds_read_b128 v[112:115], v6 offset:4096
    ds_read_b128 v[116:119], v6 offset:5120
    ds_read_b128 v[120:123], v6 offset:6144
    ds_read_b128 v[124:127], v6 offset:7168
    ds_read_b128 v[128:131], v6 offset:8192
    ds_read_b128 v[132:135], v6 offset:9216
    ds_read_b128 v[136:139], v6 offset:10240
    ds_read_b128 v[140:143], v6 offset:11264
    ds_read_b128 v[144:147], v6 offset:12288
    ds_read_b128 v[148:151], v6 offset:13312
    ds_read_b128 v[152:155], v6 offset:14336
    ds_read_b128 v[156:159], v6 offset:15360
    v_mfma_f32_32x32x16_bf16 v[48:63], v[84:87], v[80:83], 0
    s_waitcnt vmcnt(15) lgkmcnt(15)
    v_mfma_f32_32x32x16_bf16 v[48:63], a[0:3], v[96:99], v[48:63]
    s_waitcnt vmcnt(14) lgkmcnt(14)
    v_mfma_f32_32x32x16_bf16 v[48:63], a[4:7], v[100:103], v[48:63]
    s_waitcnt vmcnt(13) lgkmcnt(13)
    v_mfma_f32_32x32x16_bf16 v[48:63], a[8:11], v[104:107], v[48:63]
    s_waitcnt vmcnt(12) lgkmcnt(12)
    v_mfma_f32_32x32x16_bf16 v[48:63], a[12:15], v[108:111], v[48:63]
    s_waitcnt vmcnt(11) lgkmcnt(11)
    v_mfma_f32_32x32x16_bf16 v[48:63], a[16:19], v[112:115], v[48:63]
    s_waitcnt vmcnt(10) lgkmcnt(10)
    v_mfma_f32_32x32x16_bf16 v[48:63], a[20:23], v[116:119], v[48:63]
    s_waitcnt vmcnt(9) lgkmcnt(9)
    v_mfma_f32_32x32x16_bf16 v[48:63], a[24:27], v[120:123], v[48:63]
    s_waitcnt vmcnt(8) lgkmcnt(8)
    v_mfma_f32_32x32x16_bf16 v[48:63], a[28:31], v[124:127], v[48:63]
    s_waitcnt vmcnt(7) lgkmcnt(7)
    v_mfma_f32_32x32x16_bf16 v[48:63], a[32:35], v[128:131], v[48:63]
    s_waitcnt vmcnt(6) lgkmcnt(6)
    v_mfma_f32_32x32x16_bf16 v[48:63], a[36:39], v[132:135], v[48:63]
    s_waitcnt vmcnt(5) lgkmcnt(5)
    v_mfma_f32_32x32x16_bf16 v[48:63], a[40:43], v[136:139], v[48:63]
    s_waitcnt vmcnt(4) lgkmcnt(4)
    v_mfma_f32_32x32x16_bf16 v[48:63], a[44:47], v[140:143], v[48:63]
    s_waitcnt vmcnt(3) lgkmcnt(3)
    v_mfma_f32_32x32x16_bf16 v[48:63], a[48:51], v[144:147], v[48:63]
    s_waitcnt vmcnt(2) lgkmcnt(2)
    v_mfma_f32_32x32x16_bf16 v[48:63], a[52:55], v[148:151], v[48:63]
    s_waitcnt vmcnt(1) lgkmcnt(1)
    v_mfma_f32_32x32x16_bf16 v[48:63], a[56:59], v[152:155], v[48:63]
    s_cmp_lt_u32 s3, s57
    s_cbranch_scc1 attn_kernel_kc
    s_waitcnt vmcnt(0)
attn_kernel_kc:
    s_waitcnt vmcnt(1) lgkmcnt(0)
    v_mfma_f32_32x32x16_bf16 v[48:63], a[60:63], v[156:159], v[48:63]
    s_xor_b32 s30, s3, 4
    s_lshl_b32 s30, s30, 11
    v_add_u32 v6, s30, v1
    s_lshl_b32 s30, s3, 11
    v_add_u32 v7, s30, v1
    v_mul_f32 v12, 0x3eb8aa3b, v11
    s_lshl_b32 s40, s19, 14
    s_add_u32 s40, s40, 10788864
    s_lshl_b32 s41, s19, 15
    s_add_u32 s41, s41, 10854400
    s_nop 7
    s_cmp_eq_u32 s39, 0
    s_cbranch_scc1 attn_kernel_sw
    v_swap_b32 v48, v56
    v_swap_b32 v49, v57
    v_swap_b32 v50, v58
    v_swap_b32 v51, v59
    v_swap_b32 v52, v60
    v_swap_b32 v53, v61
    v_swap_b32 v54, v62
    v_swap_b32 v55, v63
attn_kernel_sw:
    ds_write_b128 v6, v[56:59] offset:36864
    ds_write_b128 v6, v[60:63] offset:37888
    s_and_b32 s30, s3, 3
    s_lshl_b32 s30, s30, 1
    s_add_u32 s30, s30, s39
    s_lshl_b32 s30, s30, 10
    v_add_u32 v8, s30, v1
    s_waitcnt lgkmcnt(0)
    s_barrier
    ds_read_b128 v[56:59], v7 offset:36864
    ds_read_b128 v[60:63], v7 offset:37888
    s_waitcnt lgkmcnt(0)
    v_add_f32 v48, v48, v56
    v_add_f32 v49, v49, v57
    v_add_f32 v50, v50, v58
    v_add_f32 v51, v51, v59
    v_add_f32 v52, v52, v60
    v_add_f32 v53, v53, v61
    v_add_f32 v54, v54, v62
    v_add_f32 v55, v55, v63
    v_mul_f32 v48, v48, v12
    v_mul_f32 v49, v49, v12
    v_mul_f32 v50, v50, v12
    v_mul_f32 v51, v51, v12
    v_mul_f32 v52, v52, v12
    v_mul_f32 v53, v53, v12
    v_mul_f32 v54, v54, v12
    v_mul_f32 v55, v55, v12
    v_cvt_pk_bf16_f32 v128, v48, v49
    v_cvt_pk_bf16_f32 v129, v50, v51
    v_cvt_pk_bf16_f32 v130, v52, v53
    v_cvt_pk_bf16_f32 v131, v54, v55
    ds_write_b128 v8, v[128:131] offset:4096
    s_lshl_b32 s31, s18, 2
    s_xor_b32 s30, s19, 0
    s_add_u32 s30, s30, s31
    s_lshl_b32 s30, s30, 10
    v_add_u32 v12, s30, v1
    s_xor_b32 s30, s19, 1
    s_add_u32 s30, s30, s31
    s_lshl_b32 s30, s30, 10
    v_add_u32 v13, s30, v1
    s_xor_b32 s30, s19, 2
    s_add_u32 s30, s30, s31
    s_lshl_b32 s30, s30, 10
    v_add_u32 v14, s30, v1
    s_xor_b32 s30, s19, 3
    s_add_u32 s30, s30, s31
    s_lshl_b32 s30, s30, 10
    v_add_u32 v15, s30, v1
    s_cmp_lg_u32 s3, 7
    s_cbranch_scc1 attn_kernel_pe
    buffer_load_dwordx3 v[100:102], v5, s[4:7], s28 offen sc1
attn_kernel_pe:
    s_waitcnt lgkmcnt(0)
    s_barrier
    ds_read_b128 v[16:19], v12 offset:4096
    ds_read_b128 v[20:23], v13 offset:4096
    ds_read_b128 v[24:27], v14 offset:4096
    ds_read_b128 v[28:31], v15 offset:4096
    v_mov_b32 v32, 0
    v_mov_b32 v33, 0
    v_mov_b32 v34, 0
    v_mov_b32 v35, 0
    v_mov_b32 v36, 0
    v_mov_b32 v37, 0
    v_mov_b32 v38, 0
    v_mov_b32 v39, 0
    v_mov_b32 v40, 0
    v_mov_b32 v41, 0
    v_mov_b32 v42, 0
    v_mov_b32 v43, 0
    v_mov_b32 v44, 0
    v_mov_b32 v45, 0
    v_mov_b32 v46, 0
    v_mov_b32 v47, 0
    v_mov_b32 v48, 0
    v_mov_b32 v49, 0
    v_mov_b32 v50, 0
    v_mov_b32 v51, 0
    v_mov_b32 v52, 0
    v_mov_b32 v53, 0
    v_mov_b32 v54, 0
    v_mov_b32 v55, 0
    v_mov_b32 v56, 0
    v_mov_b32 v57, 0
    v_mov_b32 v58, 0
    v_mov_b32 v59, 0
    v_mov_b32 v60, 0
    v_mov_b32 v61, 0
    v_mov_b32 v62, 0
    v_mov_b32 v63, 0
    v_mov_b32 v64, 0
    v_mov_b32 v65, 0
    v_mov_b32 v66, 0
    v_mov_b32 v67, 0
    v_mov_b32 v68, 0
    v_mov_b32 v69, 0
    v_mov_b32 v70, 0
    v_mov_b32 v71, 0
    v_mov_b32 v72, 0
    v_mov_b32 v73, 0
    v_mov_b32 v74, 0
    v_mov_b32 v75, 0
    v_mov_b32 v76, 0
    v_mov_b32 v77, 0
    v_mov_b32 v78, 0
    v_mov_b32 v79, 0
    v_mov_b32 v80, 0
    v_mov_b32 v81, 0
    v_mov_b32 v82, 0
    v_mov_b32 v83, 0
    v_mov_b32 v84, 0
    v_mov_b32 v85, 0
    v_mov_b32 v86, 0
    v_mov_b32 v87, 0
    v_mov_b32 v88, 0
    v_mov_b32 v89, 0
    v_mov_b32 v90, 0
    v_mov_b32 v91, 0
    v_mov_b32 v92, 0
    v_mov_b32 v93, 0
    v_mov_b32 v94, 0
    v_mov_b32 v95, 0
    v_mov_b32 v132, 0
    v_mov_b32 v156, 0
    v_mov_b32 v8, 0
    v_mov_b32 v133, 0
    v_mov_b32 v157, 0
    v_mov_b32 v9, 0
    v_mov_b32 v134, 0
    v_mov_b32 v158, 0
    v_mov_b32 v10, 0
    v_mov_b32 v135, 0
    v_mov_b32 v159, 0
    v_mov_b32 v11, 0
    s_waitcnt lgkmcnt(0)
    v_dot2c_f32_bf16 v8, v16, v16
    v_dot2c_f32_bf16 v8, v17, v17
    v_dot2c_f32_bf16 v8, v18, v18
    v_dot2c_f32_bf16 v8, v19, v19
    v_dot2c_f32_bf16 v9, v20, v20
    v_dot2c_f32_bf16 v9, v21, v21
    v_dot2c_f32_bf16 v9, v22, v22
    v_dot2c_f32_bf16 v9, v23, v23
    v_dot2c_f32_bf16 v10, v24, v24
    v_dot2c_f32_bf16 v10, v25, v25
    v_dot2c_f32_bf16 v10, v26, v26
    v_dot2c_f32_bf16 v10, v27, v27
    v_dot2c_f32_bf16 v11, v28, v28
    v_dot2c_f32_bf16 v11, v29, v29
    v_dot2c_f32_bf16 v11, v30, v30
    v_dot2c_f32_bf16 v11, v31, v31
    s_cmp_lg_u32 s3, 7
    s_cbranch_scc1 attn_kernel_np
    s_branch attn_kernel_pc
attn_kernel_pl:
    buffer_load_dwordx3 v[100:102], v5, s[4:7], s28 offen sc1
attn_kernel_pc:
    s_sub_u32 s34, s34, 1
    s_waitcnt vmcnt(0)
    s_cbranch_scc1 attn_kernel_pg
    v_max3_u32 v103, v100, v101, v102
    v_cmp_eq_u32 vcc, -1, v103
    s_nop 4
    s_cbranch_vccnz attn_kernel_pl
attn_kernel_pg:
    ds_write_b32 v2, v100 offset:53248
    s_waitcnt lgkmcnt(0)
attn_kernel_np:
    s_barrier
    ds_read_b32 v6, v2 offset:53248
    buffer_load_dwordx4 v[136:139], v1, s[4:7], s40 offen sc1
    buffer_load_dwordx4 v[140:143], v1, s[4:7], s41 offen sc1
    buffer_load_dwordx4 v[144:147], v1, s[4:7], s41 offen offset:1024 sc1
    s_add_u32 s40, s40, 1024
    s_add_u32 s41, s41, 2048
    s_waitcnt lgkmcnt(0)
    v_max_f32_dpp v6, v6, v6 quad_perm:[1,0,3,2] row_mask:0xf bank_mask:0xf
    s_nop 2
    v_max_f32_dpp v6, v6, v6 quad_perm:[2,3,0,1] row_mask:0xf bank_mask:0xf
    v_permlane32_swap_b32 v8, v9
    v_permlane32_swap_b32 v10, v11
    v_max_f32_dpp v6, v6, v6 row_half_mirror row_mask:0xf bank_mask:0xf
    v_add_f32 v8, v8, v9
    v_add_f32 v10, v10, v11
    v_max_f32_dpp v6, v6, v6 row_mirror row_mask:0xf bank_mask:0xf
    v_max_f32 v8, v8, v10
    s_nop 0
    v_readlane_b32 s30, v6, 0
    v_readlane_b32 s31, v6, 16
    v_readlane_b32 s32, v6, 32
    v_readlane_b32 s33, v6, 48
    s_max_u32 s30, s30, s31
    s_max_u32 s32, s32, s33
    s_max_u32 s30, s30, s32
    v_mul_f32 v8, s30, v8
    s_mov_b32 s31, 0x45610000
    v_cmp_nge_f32 vcc, s31, v8
    s_mov_b32 s34, 8
    s_nop 3
    s_cbranch_vccnz attn_kernel_slow
    v_mov_b32 v124, 0
    v_mov_b32 v125, 0
    v_mov_b32 v126, 0
    v_mov_b32 v127, 0
    s_waitcnt vmcnt(0)
    v_mfma_f32_32x32x16_bf16 v[96:111], v[136:139], v[16:19], 0
    s_nop 15
    .p2align 6
attn_kernel_loop1:
    v_exp_f32 v96, v96
    v_exp_f32 v97, v97
    v_cvt_pk_bf16_f32 v134, v124, v125
    v_exp_f32 v98, v98
    v_cvt_pk_bf16_f32 v135, v126, v127
    v_mfma_f32_32x32x16_bf16 v[112:127], v[136:139], v[20:23], 0
    v_exp_f32 v99, v99
    v_exp_f32 v100, v100
    v_cvt_pk_bf16_f32 v128, v96, v97
    v_mfma_f32_32x32x16_bf16 v[80:95], v[156:159], v[132:135], v[80:95]
    buffer_load_dwordx4 v[148:151], v1, s[4:7], s40 offen offset:0 sc1
    buffer_load_dwordx4 v[152:155], v1, s[4:7], s41 offen offset:0 sc1
    buffer_load_dwordx4 v[156:159], v1, s[4:7], s41 offen offset:1024 sc1
    buffer_load_dwordx4 a[0:3], v1, s[4:7], s43 offen offset:0
    v_exp_f32 v101, v101
    v_exp_f32 v102, v102
    v_cvt_pk_bf16_f32 v129, v98, v99
    v_exp_f32 v103, v103
    v_exp_f32 v104, v104
    v_cvt_pk_bf16_f32 v130, v100, v101
    v_exp_f32 v105, v105
    v_exp_f32 v106, v106
    v_cvt_pk_bf16_f32 v131, v102, v103
    v_exp_f32 v107, v107
    v_exp_f32 v108, v108
    v_mfma_f32_32x32x16_bf16 v[32:47], v[140:143], v[128:131], v[32:47]
    v_cvt_pk_bf16_f32 v132, v104, v105
    v_exp_f32 v109, v109
    v_exp_f32 v110, v110
    v_cvt_pk_bf16_f32 v133, v106, v107
    v_exp_f32 v111, v111
    v_exp_f32 v112, v112
    v_exp_f32 v113, v113
    v_cvt_pk_bf16_f32 v134, v108, v109
    v_exp_f32 v114, v114
    v_cvt_pk_bf16_f32 v135, v110, v111
    v_mfma_f32_32x32x16_bf16 v[96:111], v[136:139], v[24:27], 0
    v_exp_f32 v115, v115
    v_exp_f32 v116, v116
    v_cvt_pk_bf16_f32 v128, v112, v113
    v_mfma_f32_32x32x16_bf16 v[32:47], v[144:147], v[132:135], v[32:47]
    v_exp_f32 v117, v117
    v_exp_f32 v118, v118
    v_cvt_pk_bf16_f32 v129, v114, v115
    v_exp_f32 v119, v119
    v_exp_f32 v120, v120
    v_cvt_pk_bf16_f32 v130, v116, v117
    v_exp_f32 v121, v121
    v_exp_f32 v122, v122
    v_cvt_pk_bf16_f32 v131, v118, v119
    v_exp_f32 v123, v123
    v_exp_f32 v124, v124
    v_mfma_f32_32x32x16_bf16 v[48:63], v[140:143], v[128:131], v[48:63]
    v_cvt_pk_bf16_f32 v132, v120, v121
    v_exp_f32 v125, v125
    v_exp_f32 v126, v126
    v_cvt_pk_bf16_f32 v133, v122, v123
    v_exp_f32 v127, v127
    v_exp_f32 v96, v96
    v_exp_f32 v97, v97
    v_cvt_pk_bf16_f32 v134, v124, v125
    v_exp_f32 v98, v98
    v_cvt_pk_bf16_f32 v135, v126, v127
    v_mfma_f32_32x32x16_bf16 v[112:127], v[136:139], v[28:31], 0
    v_exp_f32 v99, v99
    v_exp_f32 v100, v100
    v_cvt_pk_bf16_f32 v128, v96, v97
    v_mfma_f32_32x32x16_bf16 v[48:63], v[144:147], v[132:135], v[48:63]
    v_exp_f32 v101, v101
    v_exp_f32 v102, v102
    v_cvt_pk_bf16_f32 v129, v98, v99
    v_exp_f32 v103, v103
    v_exp_f32 v104, v104
    v_cvt_pk_bf16_f32 v130, v100, v101
    v_exp_f32 v105, v105
    v_exp_f32 v106, v106
    v_cvt_pk_bf16_f32 v131, v102, v103
    v_exp_f32 v107, v107
    v_exp_f32 v108, v108
    v_mfma_f32_32x32x16_bf16 v[64:79], v[140:143], v[128:131], v[64:79]
    v_cvt_pk_bf16_f32 v132, v104, v105
    v_exp_f32 v109, v109
    v_exp_f32 v110, v110
    v_cvt_pk_bf16_f32 v133, v106, v107
    v_exp_f32 v111, v111
    v_exp_f32 v112, v112
    v_exp_f32 v113, v113
    v_cvt_pk_bf16_f32 v134, v108, v109
    v_exp_f32 v114, v114
    v_cvt_pk_bf16_f32 v135, v110, v111
    s_waitcnt vmcnt(1)
    v_mfma_f32_32x32x16_bf16 v[96:111], v[148:151], v[16:19], 0
    v_exp_f32 v115, v115
    v_exp_f32 v116, v116
    v_cvt_pk_bf16_f32 v128, v112, v113
    v_mfma_f32_32x32x16_bf16 v[64:79], v[144:147], v[132:135], v[64:79]
    v_exp_f32 v117, v117
    v_exp_f32 v118, v118
    v_cvt_pk_bf16_f32 v129, v114, v115
    v_exp_f32 v119, v119
    v_exp_f32 v120, v120
    v_cvt_pk_bf16_f32 v130, v116, v117
    v_exp_f32 v121, v121
    v_exp_f32 v122, v122
    v_cvt_pk_bf16_f32 v131, v118, v119
    v_exp_f32 v123, v123
    v_exp_f32 v124, v124
    v_mfma_f32_32x32x16_bf16 v[80:95], v[140:143], v[128:131], v[80:95]
    v_cvt_pk_bf16_f32 v132, v120, v121
    v_exp_f32 v125, v125
    v_exp_f32 v126, v126
    v_cvt_pk_bf16_f32 v133, v122, v123
    v_exp_f32 v127, v127
    v_exp_f32 v96, v96
    v_exp_f32 v97, v97
    v_cvt_pk_bf16_f32 v134, v124, v125
    v_exp_f32 v98, v98
    v_cvt_pk_bf16_f32 v135, v126, v127
    v_mfma_f32_32x32x16_bf16 v[112:127], v[148:151], v[20:23], 0
    v_exp_f32 v99, v99
    v_exp_f32 v100, v100
    v_cvt_pk_bf16_f32 v128, v96, v97
    v_mfma_f32_32x32x16_bf16 v[80:95], v[144:147], v[132:135], v[80:95]
    buffer_load_dwordx4 v[136:139], v1, s[4:7], s40 offen offset:1024 sc1
    buffer_load_dwordx4 v[140:143], v1, s[4:7], s41 offen offset:2048 sc1
    buffer_load_dwordx4 v[144:147], v1, s[4:7], s41 offen offset:3072 sc1
    buffer_load_dwordx4 a[4:7], v1, s[4:7], s43 offen offset:1024
    v_exp_f32 v101, v101
    v_exp_f32 v102, v102
    v_cvt_pk_bf16_f32 v129, v98, v99
    v_exp_f32 v103, v103
    v_exp_f32 v104, v104
    v_cvt_pk_bf16_f32 v130, v100, v101
    v_exp_f32 v105, v105
    v_exp_f32 v106, v106
    v_cvt_pk_bf16_f32 v131, v102, v103
    v_exp_f32 v107, v107
    v_exp_f32 v108, v108
    v_mfma_f32_32x32x16_bf16 v[32:47], v[152:155], v[128:131], v[32:47]
    v_cvt_pk_bf16_f32 v132, v104, v105
    v_exp_f32 v109, v109
    v_exp_f32 v110, v110
    v_cvt_pk_bf16_f32 v133, v106, v107
    v_exp_f32 v111, v111
    v_exp_f32 v112, v112
    v_exp_f32 v113, v113
    v_cvt_pk_bf16_f32 v134, v108, v109
    v_exp_f32 v114, v114
    v_cvt_pk_bf16_f32 v135, v110, v111
    v_mfma_f32_32x32x16_bf16 v[96:111], v[148:151], v[24:27], 0
    v_exp_f32 v115, v115
    v_exp_f32 v116, v116
    v_cvt_pk_bf16_f32 v128, v112, v113
    v_mfma_f32_32x32x16_bf16 v[32:47], v[156:159], v[132:135], v[32:47]
    v_exp_f32 v117, v117
    v_exp_f32 v118, v118
    v_cvt_pk_bf16_f32 v129, v114, v115
    v_exp_f32 v119, v119
    v_exp_f32 v120, v120
    v_cvt_pk_bf16_f32 v130, v116, v117
    v_exp_f32 v121, v121
    v_exp_f32 v122, v122
    v_cvt_pk_bf16_f32 v131, v118, v119
    v_exp_f32 v123, v123
    v_exp_f32 v124, v124
    v_mfma_f32_32x32x16_bf16 v[48:63], v[152:155], v[128:131], v[48:63]
    v_cvt_pk_bf16_f32 v132, v120, v121
    v_exp_f32 v125, v125
    v_exp_f32 v126, v126
    v_cvt_pk_bf16_f32 v133, v122, v123
    v_exp_f32 v127, v127
    v_exp_f32 v96, v96
    v_exp_f32 v97, v97
    v_cvt_pk_bf16_f32 v134, v124, v125
    v_exp_f32 v98, v98
    v_cvt_pk_bf16_f32 v135, v126, v127
    v_mfma_f32_32x32x16_bf16 v[112:127], v[148:151], v[28:31], 0
    v_exp_f32 v99, v99
    v_exp_f32 v100, v100
    v_cvt_pk_bf16_f32 v128, v96, v97
    v_mfma_f32_32x32x16_bf16 v[48:63], v[156:159], v[132:135], v[48:63]
    v_exp_f32 v101, v101
    v_exp_f32 v102, v102
    v_cvt_pk_bf16_f32 v129, v98, v99
    v_exp_f32 v103, v103
    v_exp_f32 v104, v104
    v_cvt_pk_bf16_f32 v130, v100, v101
    v_exp_f32 v105, v105
    v_exp_f32 v106, v106
    v_cvt_pk_bf16_f32 v131, v102, v103
    v_exp_f32 v107, v107
    v_exp_f32 v108, v108
    v_mfma_f32_32x32x16_bf16 v[64:79], v[152:155], v[128:131], v[64:79]
    v_cvt_pk_bf16_f32 v132, v104, v105
    v_exp_f32 v109, v109
    v_exp_f32 v110, v110
    v_cvt_pk_bf16_f32 v133, v106, v107
    v_exp_f32 v111, v111
    v_exp_f32 v112, v112
    v_exp_f32 v113, v113
    v_cvt_pk_bf16_f32 v134, v108, v109
    v_exp_f32 v114, v114
    v_cvt_pk_bf16_f32 v135, v110, v111
    s_waitcnt vmcnt(1)
    v_mfma_f32_32x32x16_bf16 v[96:111], v[136:139], v[16:19], 0
    v_exp_f32 v115, v115
    v_exp_f32 v116, v116
    v_cvt_pk_bf16_f32 v128, v112, v113
    v_mfma_f32_32x32x16_bf16 v[64:79], v[156:159], v[132:135], v[64:79]
    v_exp_f32 v117, v117
    v_exp_f32 v118, v118
    v_cvt_pk_bf16_f32 v129, v114, v115
    v_exp_f32 v119, v119
    v_exp_f32 v120, v120
    v_cvt_pk_bf16_f32 v130, v116, v117
    v_exp_f32 v121, v121
    v_exp_f32 v122, v122
    v_cvt_pk_bf16_f32 v131, v118, v119
    v_exp_f32 v123, v123
    v_exp_f32 v124, v124
    v_mfma_f32_32x32x16_bf16 v[80:95], v[152:155], v[128:131], v[80:95]
    v_cvt_pk_bf16_f32 v132, v120, v121
    v_exp_f32 v125, v125
    v_exp_f32 v126, v126
    v_cvt_pk_bf16_f32 v133, v122, v123
    v_exp_f32 v127, v127
    s_add_u32 s40, s40, 2048
    s_add_u32 s41, s41, 4096
    v_exp_f32 v96, v96
    v_exp_f32 v97, v97
    v_cvt_pk_bf16_f32 v134, v124, v125
    v_exp_f32 v98, v98
    v_cvt_pk_bf16_f32 v135, v126, v127
    v_mfma_f32_32x32x16_bf16 v[112:127], v[136:139], v[20:23], 0
    v_exp_f32 v99, v99
    v_exp_f32 v100, v100
    v_cvt_pk_bf16_f32 v128, v96, v97
    v_mfma_f32_32x32x16_bf16 v[80:95], v[156:159], v[132:135], v[80:95]
    buffer_load_dwordx4 v[148:151], v1, s[4:7], s40 offen offset:0 sc1
    buffer_load_dwordx4 v[152:155], v1, s[4:7], s41 offen offset:0 sc1
    buffer_load_dwordx4 v[156:159], v1, s[4:7], s41 offen offset:1024 sc1
    buffer_load_dwordx4 a[8:11], v1, s[4:7], s43 offen offset:2048
    v_exp_f32 v101, v101
    v_exp_f32 v102, v102
    v_cvt_pk_bf16_f32 v129, v98, v99
    v_exp_f32 v103, v103
    v_exp_f32 v104, v104
    v_cvt_pk_bf16_f32 v130, v100, v101
    v_exp_f32 v105, v105
    v_exp_f32 v106, v106
    v_cvt_pk_bf16_f32 v131, v102, v103
    v_exp_f32 v107, v107
    v_exp_f32 v108, v108
    v_mfma_f32_32x32x16_bf16 v[32:47], v[140:143], v[128:131], v[32:47]
    v_cvt_pk_bf16_f32 v132, v104, v105
    v_exp_f32 v109, v109
    v_exp_f32 v110, v110
    v_cvt_pk_bf16_f32 v133, v106, v107
    v_exp_f32 v111, v111
    v_exp_f32 v112, v112
    v_exp_f32 v113, v113
    v_cvt_pk_bf16_f32 v134, v108, v109
    v_exp_f32 v114, v114
    v_cvt_pk_bf16_f32 v135, v110, v111
    v_mfma_f32_32x32x16_bf16 v[96:111], v[136:139], v[24:27], 0
    v_exp_f32 v115, v115
    v_exp_f32 v116, v116
    v_cvt_pk_bf16_f32 v128, v112, v113
    v_mfma_f32_32x32x16_bf16 v[32:47], v[144:147], v[132:135], v[32:47]
    v_exp_f32 v117, v117
    v_exp_f32 v118, v118
    v_cvt_pk_bf16_f32 v129, v114, v115
    v_exp_f32 v119, v119
    v_exp_f32 v120, v120
    v_cvt_pk_bf16_f32 v130, v116, v117
    v_exp_f32 v121, v121
    v_exp_f32 v122, v122
    v_cvt_pk_bf16_f32 v131, v118, v119
    v_exp_f32 v123, v123
    v_exp_f32 v124, v124
    v_mfma_f32_32x32x16_bf16 v[48:63], v[140:143], v[128:131], v[48:63]
    v_cvt_pk_bf16_f32 v132, v120, v121
    v_exp_f32 v125, v125
    v_exp_f32 v126, v126
    v_cvt_pk_bf16_f32 v133, v122, v123
    v_exp_f32 v127, v127
    v_exp_f32 v96, v96
    v_exp_f32 v97, v97
    v_cvt_pk_bf16_f32 v134, v124, v125
    v_exp_f32 v98, v98
    v_cvt_pk_bf16_f32 v135, v126, v127
    v_mfma_f32_32x32x16_bf16 v[112:127], v[136:139], v[28:31], 0
    v_exp_f32 v99, v99
    v_exp_f32 v100, v100
    v_cvt_pk_bf16_f32 v128, v96, v97
    v_mfma_f32_32x32x16_bf16 v[48:63], v[144:147], v[132:135], v[48:63]
    v_exp_f32 v101, v101
    v_exp_f32 v102, v102
    v_cvt_pk_bf16_f32 v129, v98, v99
    v_exp_f32 v103, v103
    v_exp_f32 v104, v104
    v_cvt_pk_bf16_f32 v130, v100, v101
    v_exp_f32 v105, v105
    v_exp_f32 v106, v106
    v_cvt_pk_bf16_f32 v131, v102, v103
    v_exp_f32 v107, v107
    v_exp_f32 v108, v108
    v_mfma_f32_32x32x16_bf16 v[64:79], v[140:143], v[128:131], v[64:79]
    v_cvt_pk_bf16_f32 v132, v104, v105
    v_exp_f32 v109, v109
    v_exp_f32 v110, v110
    v_cvt_pk_bf16_f32 v133, v106, v107
    v_exp_f32 v111, v111
    v_exp_f32 v112, v112
    v_exp_f32 v113, v113
    v_cvt_pk_bf16_f32 v134, v108, v109
    v_exp_f32 v114, v114
    v_cvt_pk_bf16_f32 v135, v110, v111
    s_waitcnt vmcnt(1)
    v_mfma_f32_32x32x16_bf16 v[96:111], v[148:151], v[16:19], 0
    v_exp_f32 v115, v115
    v_exp_f32 v116, v116
    v_cvt_pk_bf16_f32 v128, v112, v113
    v_mfma_f32_32x32x16_bf16 v[64:79], v[144:147], v[132:135], v[64:79]
    v_exp_f32 v117, v117
    v_exp_f32 v118, v118
    v_cvt_pk_bf16_f32 v129, v114, v115
    v_exp_f32 v119, v119
    v_exp_f32 v120, v120
    v_cvt_pk_bf16_f32 v130, v116, v117
    v_exp_f32 v121, v121
    v_exp_f32 v122, v122
    v_cvt_pk_bf16_f32 v131, v118, v119
    v_exp_f32 v123, v123
    v_exp_f32 v124, v124
    v_mfma_f32_32x32x16_bf16 v[80:95], v[140:143], v[128:131], v[80:95]
    v_cvt_pk_bf16_f32 v132, v120, v121
    v_exp_f32 v125, v125
    v_exp_f32 v126, v126
    v_cvt_pk_bf16_f32 v133, v122, v123
    v_exp_f32 v127, v127
    v_exp_f32 v96, v96
    v_exp_f32 v97, v97
    v_cvt_pk_bf16_f32 v134, v124, v125
    v_exp_f32 v98, v98
    v_cvt_pk_bf16_f32 v135, v126, v127
    v_mfma_f32_32x32x16_bf16 v[112:127], v[148:151], v[20:23], 0
    v_exp_f32 v99, v99
    v_exp_f32 v100, v100
    v_cvt_pk_bf16_f32 v128, v96, v97
    v_mfma_f32_32x32x16_bf16 v[80:95], v[144:147], v[132:135], v[80:95]
    buffer_load_dwordx4 v[136:139], v1, s[4:7], s40 offen offset:1024 sc1
    buffer_load_dwordx4 v[140:143], v1, s[4:7], s41 offen offset:2048 sc1
    buffer_load_dwordx4 v[144:147], v1, s[4:7], s41 offen offset:3072 sc1
    buffer_load_dwordx4 a[12:15], v1, s[4:7], s43 offen offset:3072
    s_add_u32 s53, s53, 8192
    s_and_b32 s53, s53, 0x7fff
    s_add_u32 s43, s52, s53
    v_exp_f32 v101, v101
    v_exp_f32 v102, v102
    v_cvt_pk_bf16_f32 v129, v98, v99
    v_exp_f32 v103, v103
    v_exp_f32 v104, v104
    v_cvt_pk_bf16_f32 v130, v100, v101
    v_exp_f32 v105, v105
    v_exp_f32 v106, v106
    v_cvt_pk_bf16_f32 v131, v102, v103
    v_exp_f32 v107, v107
    v_exp_f32 v108, v108
    v_mfma_f32_32x32x16_bf16 v[32:47], v[152:155], v[128:131], v[32:47]
    v_cvt_pk_bf16_f32 v132, v104, v105
    v_exp_f32 v109, v109
    v_exp_f32 v110, v110
    v_cvt_pk_bf16_f32 v133, v106, v107
    v_exp_f32 v111, v111
    v_exp_f32 v112, v112
    v_exp_f32 v113, v113
    v_cvt_pk_bf16_f32 v134, v108, v109
    v_exp_f32 v114, v114
    v_cvt_pk_bf16_f32 v135, v110, v111
    v_mfma_f32_32x32x16_bf16 v[96:111], v[148:151], v[24:27], 0
    v_exp_f32 v115, v115
    v_exp_f32 v116, v116
    v_cvt_pk_bf16_f32 v128, v112, v113
    v_mfma_f32_32x32x16_bf16 v[32:47], v[156:159], v[132:135], v[32:47]
    v_exp_f32 v117, v117
    v_exp_f32 v118, v118
    v_cvt_pk_bf16_f32 v129, v114, v115
    v_exp_f32 v119, v119
    v_exp_f32 v120, v120
    v_cvt_pk_bf16_f32 v130, v116, v117
    v_exp_f32 v121, v121
    v_exp_f32 v122, v122
    v_cvt_pk_bf16_f32 v131, v118, v119
    v_exp_f32 v123, v123
    v_exp_f32 v124, v124
    v_mfma_f32_32x32x16_bf16 v[48:63], v[152:155], v[128:131], v[48:63]
    v_cvt_pk_bf16_f32 v132, v120, v121
    v_exp_f32 v125, v125
    v_exp_f32 v126, v126
    v_cvt_pk_bf16_f32 v133, v122, v123
    v_exp_f32 v127, v127
    v_exp_f32 v96, v96
    v_exp_f32 v97, v97
    v_cvt_pk_bf16_f32 v134, v124, v125
    v_exp_f32 v98, v98
    v_cvt_pk_bf16_f32 v135, v126, v127
    v_mfma_f32_32x32x16_bf16 v[112:127], v[148:151], v[28:31], 0
    v_exp_f32 v99, v99
    v_exp_f32 v100, v100
    v_cvt_pk_bf16_f32 v128, v96, v97
    v_mfma_f32_32x32x16_bf16 v[48:63], v[156:159], v[132:135], v[48:63]
    v_exp_f32 v101, v101
    v_exp_f32 v102, v102
    v_cvt_pk_bf16_f32 v129, v98, v99
    v_exp_f32 v103, v103
    v_exp_f32 v104, v104
    v_cvt_pk_bf16_f32 v130, v100, v101
    v_exp_f32 v105, v105
    v_exp_f32 v106, v106
    v_cvt_pk_bf16_f32 v131, v102, v103
    v_exp_f32 v107, v107
    v_exp_f32 v108, v108
    v_mfma_f32_32x32x16_bf16 v[64:79], v[152:155], v[128:131], v[64:79]
    v_cvt_pk_bf16_f32 v132, v104, v105
    v_exp_f32 v109, v109
    v_exp_f32 v110, v110
    v_cvt_pk_bf16_f32 v133, v106, v107
    v_exp_f32 v111, v111
    v_exp_f32 v112, v112
    v_exp_f32 v113, v113
    v_cvt_pk_bf16_f32 v134, v108, v109
    v_exp_f32 v114, v114
    v_cvt_pk_bf16_f32 v135, v110, v111
    s_waitcnt vmcnt(1)
    v_mfma_f32_32x32x16_bf16 v[96:111], v[136:139], v[16:19], 0
    v_exp_f32 v115, v115
    v_exp_f32 v116, v116
    v_cvt_pk_bf16_f32 v128, v112, v113
    v_mfma_f32_32x32x16_bf16 v[64:79], v[156:159], v[132:135], v[64:79]
    v_exp_f32 v117, v117
    v_exp_f32 v118, v118
    v_cvt_pk_bf16_f32 v129, v114, v115
    v_exp_f32 v119, v119
    v_exp_f32 v120, v120
    v_cvt_pk_bf16_f32 v130, v116, v117
    v_exp_f32 v121, v121
    v_exp_f32 v122, v122
    v_cvt_pk_bf16_f32 v131, v118, v119
    v_exp_f32 v123, v123
    v_exp_f32 v124, v124
    v_mfma_f32_32x32x16_bf16 v[80:95], v[152:155], v[128:131], v[80:95]
    v_cvt_pk_bf16_f32 v132, v120, v121
    v_exp_f32 v125, v125
    v_exp_f32 v126, v126
    v_cvt_pk_bf16_f32 v133, v122, v123
    v_exp_f32 v127, v127
    s_add_u32 s40, s40, 2048
    s_add_u32 s41, s41, 4096
    v_exp_f32 v96, v96
    v_exp_f32 v97, v97
    v_cvt_pk_bf16_f32 v134, v124, v125
    v_exp_f32 v98, v98
    v_cvt_pk_bf16_f32 v135, v126, v127
    v_mfma_f32_32x32x16_bf16 v[112:127], v[136:139], v[20:23], 0
    v_exp_f32 v99, v99
    v_exp_f32 v100, v100
    v_cvt_pk_bf16_f32 v128, v96, v97
    v_mfma_f32_32x32x16_bf16 v[80:95], v[156:159], v[132:135], v[80:95]
    buffer_load_dwordx4 v[148:151], v1, s[4:7], s40 offen offset:0 sc1
    buffer_load_dwordx4 v[152:155], v1, s[4:7], s41 offen offset:0 sc1
    buffer_load_dwordx4 v[156:159], v1, s[4:7], s41 offen offset:1024 sc1
    buffer_load_dwordx4 a[16:19], v1, s[4:7], s43 offen offset:0
    buffer_load_dwordx4 v[164:167], v1, s[8:11], s42 offen
    s_add_u32 s42, s42, 0x40000
    v_exp_f32 v101, v101
    v_exp_f32 v102, v102
    v_cvt_pk_bf16_f32 v129, v98, v99
    v_exp_f32 v103, v103
    v_exp_f32 v104, v104
    v_cvt_pk_bf16_f32 v130, v100, v101
    v_exp_f32 v105, v105
    v_exp_f32 v106, v106
    v_cvt_pk_bf16_f32 v131, v102, v103
    v_exp_f32 v107, v107
    v_exp_f32 v108, v108
    v_mfma_f32_32x32x16_bf16 v[32:47], v[140:143], v[128:131], v[32:47]
    v_cvt_pk_bf16_f32 v132, v104, v105
    v_exp_f32 v109, v109
    v_exp_f32 v110, v110
    v_cvt_pk_bf16_f32 v133, v106, v107
    v_exp_f32 v111, v111
    v_exp_f32 v112, v112
    v_exp_f32 v113, v113
    v_cvt_pk_bf16_f32 v134, v108, v109
    v_exp_f32 v114, v114
    v_cvt_pk_bf16_f32 v135, v110, v111
    v_mfma_f32_32x32x16_bf16 v[96:111], v[136:139], v[24:27], 0
    v_exp_f32 v115, v115
    v_exp_f32 v116, v116
    v_cvt_pk_bf16_f32 v128, v112, v113
    v_mfma_f32_32x32x16_bf16 v[32:47], v[144:147], v[132:135], v[32:47]
    v_exp_f32 v117, v117
    v_exp_f32 v118, v118
    v_cvt_pk_bf16_f32 v129, v114, v115
    v_exp_f32 v119, v119
    v_exp_f32 v120, v120
    v_cvt_pk_bf16_f32 v130, v116, v117
    v_exp_f32 v121, v121
    v_exp_f32 v122, v122
    v_cvt_pk_bf16_f32 v131, v118, v119
    v_exp_f32 v123, v123
    v_exp_f32 v124, v124
    v_mfma_f32_32x32x16_bf16 v[48:63], v[140:143], v[128:131], v[48:63]
    v_cvt_pk_bf16_f32 v132, v120, v121
    v_exp_f32 v125, v125
    v_exp_f32 v126, v126
    v_cvt_pk_bf16_f32 v133, v122, v123
    v_exp_f32 v127, v127
    v_exp_f32 v96, v96
    v_exp_f32 v97, v97
    v_cvt_pk_bf16_f32 v134, v124, v125
    v_exp_f32 v98, v98
    v_cvt_pk_bf16_f32 v135, v126, v127
    v_mfma_f32_32x32x16_bf16 v[112:127], v[136:139], v[28:31], 0
    v_exp_f32 v99, v99
    v_exp_f32 v100, v100
    v_cvt_pk_bf16_f32 v128, v96, v97
    v_mfma_f32_32x32x16_bf16 v[48:63], v[144:147], v[132:135], v[48:63]
    v_exp_f32 v101, v101
    v_exp_f32 v102, v102
    v_cvt_pk_bf16_f32 v129, v98, v99
    v_exp_f32 v103, v103
    v_exp_f32 v104, v104
    v_cvt_pk_bf16_f32 v130, v100, v101
    v_exp_f32 v105, v105
    v_exp_f32 v106, v106
    v_cvt_pk_bf16_f32 v131, v102, v103
    v_exp_f32 v107, v107
    v_exp_f32 v108, v108
    v_mfma_f32_32x32x16_bf16 v[64:79], v[140:143], v[128:131], v[64:79]
    v_cvt_pk_bf16_f32 v132, v104, v105
    v_exp_f32 v109, v109
    v_exp_f32 v110, v110
    v_cvt_pk_bf16_f32 v133, v106, v107
    v_exp_f32 v111, v111
    v_exp_f32 v112, v112
    v_exp_f32 v113, v113
    v_cvt_pk_bf16_f32 v134, v108, v109
    v_exp_f32 v114, v114
    v_cvt_pk_bf16_f32 v135, v110, v111
    s_waitcnt vmcnt(2)
    v_mfma_f32_32x32x16_bf16 v[96:111], v[148:151], v[16:19], 0
    v_exp_f32 v115, v115
    v_exp_f32 v116, v116
    v_cvt_pk_bf16_f32 v128, v112, v113
    v_mfma_f32_32x32x16_bf16 v[64:79], v[144:147], v[132:135], v[64:79]
    v_exp_f32 v117, v117
    v_exp_f32 v118, v118
    v_cvt_pk_bf16_f32 v129, v114, v115
    v_exp_f32 v119, v119
    v_exp_f32 v120, v120
    v_cvt_pk_bf16_f32 v130, v116, v117
    v_exp_f32 v121, v121
    v_exp_f32 v122, v122
    v_cvt_pk_bf16_f32 v131, v118, v119
    v_exp_f32 v123, v123
    v_exp_f32 v124, v124
    v_mfma_f32_32x32x16_bf16 v[80:95], v[140:143], v[128:131], v[80:95]
    v_cvt_pk_bf16_f32 v132, v120, v121
    v_exp_f32 v125, v125
    v_exp_f32 v126, v126
    v_cvt_pk_bf16_f32 v133, v122, v123
    v_exp_f32 v127, v127
    v_exp_f32 v96, v96
    v_exp_f32 v97, v97
    v_cvt_pk_bf16_f32 v134, v124, v125
    v_exp_f32 v98, v98
    v_cvt_pk_bf16_f32 v135, v126, v127
    v_mfma_f32_32x32x16_bf16 v[112:127], v[148:151], v[20:23], 0
    v_exp_f32 v99, v99
    v_exp_f32 v100, v100
    v_cvt_pk_bf16_f32 v128, v96, v97
    v_mfma_f32_32x32x16_bf16 v[80:95], v[144:147], v[132:135], v[80:95]
    buffer_load_dwordx4 v[136:139], v1, s[4:7], s40 offen offset:1024 sc1
    buffer_load_dwordx4 v[140:143], v1, s[4:7], s41 offen offset:2048 sc1
    buffer_load_dwordx4 v[144:147], v1, s[4:7], s41 offen offset:3072 sc1
    buffer_load_dwordx4 a[20:23], v1, s[4:7], s43 offen offset:1024
    buffer_load_dwordx4 v[164:167], v1, s[8:11], s42 offen
    s_add_u32 s42, s42, 0x40000
    v_exp_f32 v101, v101
    v_exp_f32 v102, v102
    v_cvt_pk_bf16_f32 v129, v98, v99
    v_exp_f32 v103, v103
    v_exp_f32 v104, v104
    v_cvt_pk_bf16_f32 v130, v100, v101
    v_exp_f32 v105, v105
    v_exp_f32 v106, v106
    v_cvt_pk_bf16_f32 v131, v102, v103
    v_exp_f32 v107, v107
    v_exp_f32 v108, v108
    v_mfma_f32_32x32x16_bf16 v[32:47], v[152:155], v[128:131], v[32:47]
    v_cvt_pk_bf16_f32 v132, v104, v105
    v_exp_f32 v109, v109
    v_exp_f32 v110, v110
    v_cvt_pk_bf16_f32 v133, v106, v107
    v_exp_f32 v111, v111
    v_exp_f32 v112, v112
    v_exp_f32 v113, v113
    v_cvt_pk_bf16_f32 v134, v108, v109
    v_exp_f32 v114, v114
    v_cvt_pk_bf16_f32 v135, v110, v111
    v_mfma_f32_32x32x16_bf16 v[96:111], v[148:151], v[24:27], 0
    v_exp_f32 v115, v115
    v_exp_f32 v116, v116
    v_cvt_pk_bf16_f32 v128, v112, v113
    v_mfma_f32_32x32x16_bf16 v[32:47], v[156:159], v[132:135], v[32:47]
    v_exp_f32 v117, v117
    v_exp_f32 v118, v118
    v_cvt_pk_bf16_f32 v129, v114, v115
    v_exp_f32 v119, v119
    v_exp_f32 v120, v120
    v_cvt_pk_bf16_f32 v130, v116, v117
    v_exp_f32 v121, v121
    v_exp_f32 v122, v122
    v_cvt_pk_bf16_f32 v131, v118, v119
    v_exp_f32 v123, v123
    v_exp_f32 v124, v124
    v_mfma_f32_32x32x16_bf16 v[48:63], v[152:155], v[128:131], v[48:63]
    v_cvt_pk_bf16_f32 v132, v120, v121
    v_exp_f32 v125, v125
    v_exp_f32 v126, v126
    v_cvt_pk_bf16_f32 v133, v122, v123
    v_exp_f32 v127, v127
    v_exp_f32 v96, v96
    v_exp_f32 v97, v97
    v_cvt_pk_bf16_f32 v134, v124, v125
    v_exp_f32 v98, v98
    v_cvt_pk_bf16_f32 v135, v126, v127
    v_mfma_f32_32x32x16_bf16 v[112:127], v[148:151], v[28:31], 0
    v_exp_f32 v99, v99
    v_exp_f32 v100, v100
    v_cvt_pk_bf16_f32 v128, v96, v97
    v_mfma_f32_32x32x16_bf16 v[48:63], v[156:159], v[132:135], v[48:63]
    v_exp_f32 v101, v101
    v_exp_f32 v102, v102
    v_cvt_pk_bf16_f32 v129, v98, v99
    v_exp_f32 v103, v103
    v_exp_f32 v104, v104
    v_cvt_pk_bf16_f32 v130, v100, v101
    v_exp_f32 v105, v105
    v_exp_f32 v106, v106
    v_cvt_pk_bf16_f32 v131, v102, v103
    v_exp_f32 v107, v107
    v_exp_f32 v108, v108
    v_mfma_f32_32x32x16_bf16 v[64:79], v[152:155], v[128:131], v[64:79]
    v_cvt_pk_bf16_f32 v132, v104, v105
    v_exp_f32 v109, v109
    v_exp_f32 v110, v110
    v_cvt_pk_bf16_f32 v133, v106, v107
    v_exp_f32 v111, v111
    v_exp_f32 v112, v112
    v_exp_f32 v113, v113
    v_cvt_pk_bf16_f32 v134, v108, v109
    v_exp_f32 v114, v114
    v_cvt_pk_bf16_f32 v135, v110, v111
    s_waitcnt vmcnt(2)
    v_mfma_f32_32x32x16_bf16 v[96:111], v[136:139], v[16:19], 0
    v_exp_f32 v115, v115
    v_exp_f32 v116, v116
    v_cvt_pk_bf16_f32 v128, v112, v113
    v_mfma_f32_32x32x16_bf16 v[64:79], v[156:159], v[132:135], v[64:79]
    v_exp_f32 v117, v117
    v_exp_f32 v118, v118
    v_cvt_pk_bf16_f32 v129, v114, v115
    v_exp_f32 v119, v119
    v_exp_f32 v120, v120
    v_cvt_pk_bf16_f32 v130, v116, v117
    v_exp_f32 v121, v121
    v_exp_f32 v122, v122
    v_cvt_pk_bf16_f32 v131, v118, v119
    v_exp_f32 v123, v123
    v_exp_f32 v124, v124
    v_mfma_f32_32x32x16_bf16 v[80:95], v[152:155], v[128:131], v[80:95]
    v_cvt_pk_bf16_f32 v132, v120, v121
    v_exp_f32 v125, v125
    v_exp_f32 v126, v126
    v_cvt_pk_bf16_f32 v133, v122, v123
    v_exp_f32 v127, v127
    s_add_u32 s40, s40, 2048
    s_add_u32 s41, s41, 4096
    v_exp_f32 v96, v96
    v_exp_f32 v97, v97
    v_cvt_pk_bf16_f32 v134, v124, v125
    v_exp_f32 v98, v98
    v_cvt_pk_bf16_f32 v135, v126, v127
    v_mfma_f32_32x32x16_bf16 v[112:127], v[136:139], v[20:23], 0
    v_exp_f32 v99, v99
    v_exp_f32 v100, v100
    v_cvt_pk_bf16_f32 v128, v96, v97
    v_mfma_f32_32x32x16_bf16 v[80:95], v[156:159], v[132:135], v[80:95]
    buffer_load_dwordx4 v[148:151], v1, s[4:7], s40 offen offset:0 sc1
    buffer_load_dwordx4 v[152:155], v1, s[4:7], s41 offen offset:0 sc1
    buffer_load_dwordx4 v[156:159], v1, s[4:7], s41 offen offset:1024 sc1
    buffer_load_dwordx4 a[24:27], v1, s[4:7], s43 offen offset:2048
    buffer_load_dwordx4 v[164:167], v1, s[8:11], s42 offen
    s_add_u32 s42, s42, 0x40000
    v_exp_f32 v101, v101
    v_exp_f32 v102, v102
    v_cvt_pk_bf16_f32 v129, v98, v99
    v_exp_f32 v103, v103
    v_exp_f32 v104, v104
    v_cvt_pk_bf16_f32 v130, v100, v101
    v_exp_f32 v105, v105
    v_exp_f32 v106, v106
    v_cvt_pk_bf16_f32 v131, v102, v103
    v_exp_f32 v107, v107
    v_exp_f32 v108, v108
    v_mfma_f32_32x32x16_bf16 v[32:47], v[140:143], v[128:131], v[32:47]
    v_cvt_pk_bf16_f32 v132, v104, v105
    v_exp_f32 v109, v109
    v_exp_f32 v110, v110
    v_cvt_pk_bf16_f32 v133, v106, v107
    v_exp_f32 v111, v111
    v_exp_f32 v112, v112
    v_exp_f32 v113, v113
    v_cvt_pk_bf16_f32 v134, v108, v109
    v_exp_f32 v114, v114
    v_cvt_pk_bf16_f32 v135, v110, v111
    v_mfma_f32_32x32x16_bf16 v[96:111], v[136:139], v[24:27], 0
    v_exp_f32 v115, v115
    v_exp_f32 v116, v116
    v_cvt_pk_bf16_f32 v128, v112, v113
    v_mfma_f32_32x32x16_bf16 v[32:47], v[144:147], v[132:135], v[32:47]
    v_exp_f32 v117, v117
    v_exp_f32 v118, v118
    v_cvt_pk_bf16_f32 v129, v114, v115
    v_exp_f32 v119, v119
    v_exp_f32 v120, v120
    v_cvt_pk_bf16_f32 v130, v116, v117
    v_exp_f32 v121, v121
    v_exp_f32 v122, v122
    v_cvt_pk_bf16_f32 v131, v118, v119
    v_exp_f32 v123, v123
    v_exp_f32 v124, v124
    v_mfma_f32_32x32x16_bf16 v[48:63], v[140:143], v[128:131], v[48:63]
    v_cvt_pk_bf16_f32 v132, v120, v121
    v_exp_f32 v125, v125
    v_exp_f32 v126, v126
    v_cvt_pk_bf16_f32 v133, v122, v123
    v_exp_f32 v127, v127
    v_exp_f32 v96, v96
    v_exp_f32 v97, v97
    v_cvt_pk_bf16_f32 v134, v124, v125
    v_exp_f32 v98, v98
    v_cvt_pk_bf16_f32 v135, v126, v127
    v_mfma_f32_32x32x16_bf16 v[112:127], v[136:139], v[28:31], 0
    v_exp_f32 v99, v99
    v_exp_f32 v100, v100
    v_cvt_pk_bf16_f32 v128, v96, v97
    v_mfma_f32_32x32x16_bf16 v[48:63], v[144:147], v[132:135], v[48:63]
    v_exp_f32 v101, v101
    v_exp_f32 v102, v102
    v_cvt_pk_bf16_f32 v129, v98, v99
    v_exp_f32 v103, v103
    v_exp_f32 v104, v104
    v_cvt_pk_bf16_f32 v130, v100, v101
    v_exp_f32 v105, v105
    v_exp_f32 v106, v106
    v_cvt_pk_bf16_f32 v131, v102, v103
    v_exp_f32 v107, v107
    v_exp_f32 v108, v108
    v_mfma_f32_32x32x16_bf16 v[64:79], v[140:143], v[128:131], v[64:79]
    v_cvt_pk_bf16_f32 v132, v104, v105
    v_exp_f32 v109, v109
    v_exp_f32 v110, v110
    v_cvt_pk_bf16_f32 v133, v106, v107
    v_exp_f32 v111, v111
    v_exp_f32 v112, v112
    v_exp_f32 v113, v113
    v_cvt_pk_bf16_f32 v134, v108, v109
    v_exp_f32 v114, v114
    v_cvt_pk_bf16_f32 v135, v110, v111
    s_waitcnt vmcnt(2)
    v_mfma_f32_32x32x16_bf16 v[96:111], v[148:151], v[16:19], 0
    v_exp_f32 v115, v115
    v_exp_f32 v116, v116
    v_cvt_pk_bf16_f32 v128, v112, v113
    v_mfma_f32_32x32x16_bf16 v[64:79], v[144:147], v[132:135], v[64:79]
    v_exp_f32 v117, v117
    v_exp_f32 v118, v118
    v_cvt_pk_bf16_f32 v129, v114, v115
    v_exp_f32 v119, v119
    v_exp_f32 v120, v120
    v_cvt_pk_bf16_f32 v130, v116, v117
    v_exp_f32 v121, v121
    v_exp_f32 v122, v122
    v_cvt_pk_bf16_f32 v131, v118, v119
    v_exp_f32 v123, v123
    v_exp_f32 v124, v124
    v_mfma_f32_32x32x16_bf16 v[80:95], v[140:143], v[128:131], v[80:95]
    v_cvt_pk_bf16_f32 v132, v120, v121
    v_exp_f32 v125, v125
    v_exp_f32 v126, v126
    v_cvt_pk_bf16_f32 v133, v122, v123
    v_exp_f32 v127, v127
    v_exp_f32 v96, v96
    v_exp_f32 v97, v97
    v_cvt_pk_bf16_f32 v134, v124, v125
    v_exp_f32 v98, v98
    v_cvt_pk_bf16_f32 v135, v126, v127
    v_mfma_f32_32x32x16_bf16 v[112:127], v[148:151], v[20:23], 0
    v_exp_f32 v99, v99
    v_exp_f32 v100, v100
    v_cvt_pk_bf16_f32 v128, v96, v97
    v_mfma_f32_32x32x16_bf16 v[80:95], v[144:147], v[132:135], v[80:95]
    buffer_load_dwordx4 v[136:139], v1, s[4:7], s40 offen offset:1024 sc1
    buffer_load_dwordx4 v[140:143], v1, s[4:7], s41 offen offset:2048 sc1
    buffer_load_dwordx4 v[144:147], v1, s[4:7], s41 offen offset:3072 sc1
    buffer_load_dwordx4 a[28:31], v1, s[4:7], s43 offen offset:3072
    s_add_u32 s53, s53, 8192
    s_and_b32 s53, s53, 0x7fff
    s_add_u32 s43, s52, s53
    buffer_load_dwordx4 v[164:167], v1, s[8:11], s42 offen
    s_add_u32 s42, s42, 0x40000
    v_exp_f32 v101, v101
    v_exp_f32 v102, v102
    v_cvt_pk_bf16_f32 v129, v98, v99
    v_exp_f32 v103, v103
    v_exp_f32 v104, v104
    v_cvt_pk_bf16_f32 v130, v100, v101
    v_exp_f32 v105, v105
    v_exp_f32 v106, v106
    v_cvt_pk_bf16_f32 v131, v102, v103
    v_exp_f32 v107, v107
    v_exp_f32 v108, v108
    v_mfma_f32_32x32x16_bf16 v[32:47], v[152:155], v[128:131], v[32:47]
    v_cvt_pk_bf16_f32 v132, v104, v105
    v_exp_f32 v109, v109
    v_exp_f32 v110, v110
    v_cvt_pk_bf16_f32 v133, v106, v107
    v_exp_f32 v111, v111
    v_exp_f32 v112, v112
    v_exp_f32 v113, v113
    v_cvt_pk_bf16_f32 v134, v108, v109
    v_exp_f32 v114, v114
    v_cvt_pk_bf16_f32 v135, v110, v111
    v_mfma_f32_32x32x16_bf16 v[96:111], v[148:151], v[24:27], 0
    v_exp_f32 v115, v115
    v_exp_f32 v116, v116
    v_cvt_pk_bf16_f32 v128, v112, v113
    v_mfma_f32_32x32x16_bf16 v[32:47], v[156:159], v[132:135], v[32:47]
    v_exp_f32 v117, v117
    v_exp_f32 v118, v118
    v_cvt_pk_bf16_f32 v129, v114, v115
    v_exp_f32 v119, v119
    v_exp_f32 v120, v120
    v_cvt_pk_bf16_f32 v130, v116, v117
    v_exp_f32 v121, v121
    v_exp_f32 v122, v122
    v_cvt_pk_bf16_f32 v131, v118, v119
    v_exp_f32 v123, v123
    v_exp_f32 v124, v124
    v_mfma_f32_32x32x16_bf16 v[48:63], v[152:155], v[128:131], v[48:63]
    v_cvt_pk_bf16_f32 v132, v120, v121
    v_exp_f32 v125, v125
    v_exp_f32 v126, v126
    v_cvt_pk_bf16_f32 v133, v122, v123
    v_exp_f32 v127, v127
    v_exp_f32 v96, v96
    v_exp_f32 v97, v97
    v_cvt_pk_bf16_f32 v134, v124, v125
    v_exp_f32 v98, v98
    v_cvt_pk_bf16_f32 v135, v126, v127
    v_mfma_f32_32x32x16_bf16 v[112:127], v[148:151], v[28:31], 0
    v_exp_f32 v99, v99
    v_exp_f32 v100, v100
    v_cvt_pk_bf16_f32 v128, v96, v97
    v_mfma_f32_32x32x16_bf16 v[48:63], v[156:159], v[132:135], v[48:63]
    v_exp_f32 v101, v101
    v_exp_f32 v102, v102
    v_cvt_pk_bf16_f32 v129, v98, v99
    v_exp_f32 v103, v103
    v_exp_f32 v104, v104
    v_cvt_pk_bf16_f32 v130, v100, v101
    v_exp_f32 v105, v105
    v_exp_f32 v106, v106
    v_cvt_pk_bf16_f32 v131, v102, v103
    v_exp_f32 v107, v107
    v_exp_f32 v108, v108
    v_mfma_f32_32x32x16_bf16 v[64:79], v[152:155], v[128:131], v[64:79]
    v_cvt_pk_bf16_f32 v132, v104, v105
    v_exp_f32 v109, v109
    v_exp_f32 v110, v110
    v_cvt_pk_bf16_f32 v133, v106, v107
    v_exp_f32 v111, v111
    v_exp_f32 v112, v112
    v_exp_f32 v113, v113
    v_cvt_pk_bf16_f32 v134, v108, v109
    v_exp_f32 v114, v114
    v_cvt_pk_bf16_f32 v135, v110, v111
    s_waitcnt vmcnt(2)
    v_mfma_f32_32x32x16_bf16 v[96:111], v[136:139], v[16:19], 0
    v_exp_f32 v115, v115
    v_exp_f32 v116, v116
    v_cvt_pk_bf16_f32 v128, v112, v113
    v_mfma_f32_32x32x16_bf16 v[64:79], v[156:159], v[132:135], v[64:79]
    v_exp_f32 v117, v117
    v_exp_f32 v118, v118
    v_cvt_pk_bf16_f32 v129, v114, v115
    v_exp_f32 v119, v119
    v_exp_f32 v120, v120
    v_cvt_pk_bf16_f32 v130, v116, v117
    v_exp_f32 v121, v121
    v_exp_f32 v122, v122
    v_cvt_pk_bf16_f32 v131, v118, v119
    v_exp_f32 v123, v123
    v_exp_f32 v124, v124
    v_mfma_f32_32x32x16_bf16 v[80:95], v[152:155], v[128:131], v[80:95]
    v_cvt_pk_bf16_f32 v132, v120, v121
    v_exp_f32 v125, v125
    v_exp_f32 v126, v126
    v_cvt_pk_bf16_f32 v133, v122, v123
    v_exp_f32 v127, v127
    s_add_u32 s40, s40, 2048
    s_add_u32 s41, s41, 4096
    v_exp_f32 v96, v96
    v_exp_f32 v97, v97
    v_cvt_pk_bf16_f32 v134, v124, v125
    v_exp_f32 v98, v98
    v_cvt_pk_bf16_f32 v135, v126, v127
    v_mfma_f32_32x32x16_bf16 v[112:127], v[136:139], v[20:23], 0
    v_exp_f32 v99, v99
    v_exp_f32 v100, v100
    v_cvt_pk_bf16_f32 v128, v96, v97
    v_mfma_f32_32x32x16_bf16 v[80:95], v[156:159], v[132:135], v[80:95]
    buffer_load_dwordx4 v[148:151], v1, s[4:7], s40 offen offset:0 sc1
    buffer_load_dwordx4 v[152:155], v1, s[4:7], s41 offen offset:0 sc1
    buffer_load_dwordx4 v[156:159], v1, s[4:7], s41 offen offset:1024 sc1
    buffer_load_dwordx4 a[32:35], v1, s[4:7], s43 offen offset:0
    buffer_load_dwordx4 v[164:167], v1, s[8:11], s42 offen
    s_add_u32 s42, s42, 0x40000
    v_exp_f32 v101, v101
    v_exp_f32 v102, v102
    v_cvt_pk_bf16_f32 v129, v98, v99
    v_exp_f32 v103, v103
    v_exp_f32 v104, v104
    v_cvt_pk_bf16_f32 v130, v100, v101
    v_exp_f32 v105, v105
    v_exp_f32 v106, v106
    v_cvt_pk_bf16_f32 v131, v102, v103
    v_exp_f32 v107, v107
    v_exp_f32 v108, v108
    v_mfma_f32_32x32x16_bf16 v[32:47], v[140:143], v[128:131], v[32:47]
    v_cvt_pk_bf16_f32 v132, v104, v105
    v_exp_f32 v109, v109
    v_exp_f32 v110, v110
    v_cvt_pk_bf16_f32 v133, v106, v107
    v_exp_f32 v111, v111
    v_exp_f32 v112, v112
    v_exp_f32 v113, v113
    v_cvt_pk_bf16_f32 v134, v108, v109
    v_exp_f32 v114, v114
    v_cvt_pk_bf16_f32 v135, v110, v111
    v_mfma_f32_32x32x16_bf16 v[96:111], v[136:139], v[24:27], 0
    v_exp_f32 v115, v115
    v_exp_f32 v116, v116
    v_cvt_pk_bf16_f32 v128, v112, v113
    v_mfma_f32_32x32x16_bf16 v[32:47], v[144:147], v[132:135], v[32:47]
    v_exp_f32 v117, v117
    v_exp_f32 v118, v118
    v_cvt_pk_bf16_f32 v129, v114, v115
    v_exp_f32 v119, v119
    v_exp_f32 v120, v120
    v_cvt_pk_bf16_f32 v130, v116, v117
    v_exp_f32 v121, v121
    v_exp_f32 v122, v122
    v_cvt_pk_bf16_f32 v131, v118, v119
    v_exp_f32 v123, v123
    v_exp_f32 v124, v124
    v_mfma_f32_32x32x16_bf16 v[48:63], v[140:143], v[128:131], v[48:63]
    v_cvt_pk_bf16_f32 v132, v120, v121
    v_exp_f32 v125, v125
    v_exp_f32 v126, v126
    v_cvt_pk_bf16_f32 v133, v122, v123
    v_exp_f32 v127, v127
    v_exp_f32 v96, v96
    v_exp_f32 v97, v97
    v_cvt_pk_bf16_f32 v134, v124, v125
    v_exp_f32 v98, v98
    v_cvt_pk_bf16_f32 v135, v126, v127
    v_mfma_f32_32x32x16_bf16 v[112:127], v[136:139], v[28:31], 0
    v_exp_f32 v99, v99
    v_exp_f32 v100, v100
    v_cvt_pk_bf16_f32 v128, v96, v97
    v_mfma_f32_32x32x16_bf16 v[48:63], v[144:147], v[132:135], v[48:63]
    v_exp_f32 v101, v101
    v_exp_f32 v102, v102
    v_cvt_pk_bf16_f32 v129, v98, v99
    v_exp_f32 v103, v103
    v_exp_f32 v104, v104
    v_cvt_pk_bf16_f32 v130, v100, v101
    v_exp_f32 v105, v105
    v_exp_f32 v106, v106
    v_cvt_pk_bf16_f32 v131, v102, v103
    v_exp_f32 v107, v107
    v_exp_f32 v108, v108
    v_mfma_f32_32x32x16_bf16 v[64:79], v[140:143], v[128:131], v[64:79]
    v_cvt_pk_bf16_f32 v132, v104, v105
    v_exp_f32 v109, v109
    v_exp_f32 v110, v110
    v_cvt_pk_bf16_f32 v133, v106, v107
    v_exp_f32 v111, v111
    v_exp_f32 v112, v112
    v_exp_f32 v113, v113
    v_cvt_pk_bf16_f32 v134, v108, v109
    v_exp_f32 v114, v114
    v_cvt_pk_bf16_f32 v135, v110, v111
    s_waitcnt vmcnt(2)
    v_mfma_f32_32x32x16_bf16 v[96:111], v[148:151], v[16:19], 0
    v_exp_f32 v115, v115
    v_exp_f32 v116, v116
    v_cvt_pk_bf16_f32 v128, v112, v113
    v_mfma_f32_32x32x16_bf16 v[64:79], v[144:147], v[132:135], v[64:79]
    v_exp_f32 v117, v117
    v_exp_f32 v118, v118
    v_cvt_pk_bf16_f32 v129, v114, v115
    v_exp_f32 v119, v119
    v_exp_f32 v120, v120
    v_cvt_pk_bf16_f32 v130, v116, v117
    v_exp_f32 v121, v121
    v_exp_f32 v122, v122
    v_cvt_pk_bf16_f32 v131, v118, v119
    v_exp_f32 v123, v123
    v_exp_f32 v124, v124
    v_mfma_f32_32x32x16_bf16 v[80:95], v[140:143], v[128:131], v[80:95]
    v_cvt_pk_bf16_f32 v132, v120, v121
    v_exp_f32 v125, v125
    v_exp_f32 v126, v126
    v_cvt_pk_bf16_f32 v133, v122, v123
    v_exp_f32 v127, v127
    v_exp_f32 v96, v96
    v_exp_f32 v97, v97
    v_cvt_pk_bf16_f32 v134, v124, v125
    v_exp_f32 v98, v98
    v_cvt_pk_bf16_f32 v135, v126, v127
    v_mfma_f32_32x32x16_bf16 v[112:127], v[148:151], v[20:23], 0
    v_exp_f32 v99, v99
    v_exp_f32 v100, v100
    v_cvt_pk_bf16_f32 v128, v96, v97
    v_mfma_f32_32x32x16_bf16 v[80:95], v[144:147], v[132:135], v[80:95]
    buffer_load_dwordx4 v[136:139], v1, s[4:7], s40 offen offset:1024 sc1
    buffer_load_dwordx4 v[140:143], v1, s[4:7], s41 offen offset:2048 sc1
    buffer_load_dwordx4 v[144:147], v1, s[4:7], s41 offen offset:3072 sc1
    buffer_load_dwordx4 a[36:39], v1, s[4:7], s43 offen offset:1024
    buffer_load_dwordx4 v[164:167], v1, s[8:11], s42 offen
    s_add_u32 s42, s42, 0x40000
    v_exp_f32 v101, v101
    v_exp_f32 v102, v102
    v_cvt_pk_bf16_f32 v129, v98, v99
    v_exp_f32 v103, v103
    v_exp_f32 v104, v104
    v_cvt_pk_bf16_f32 v130, v100, v101
    v_exp_f32 v105, v105
    v_exp_f32 v106, v106
    v_cvt_pk_bf16_f32 v131, v102, v103
    v_exp_f32 v107, v107
    v_exp_f32 v108, v108
    v_mfma_f32_32x32x16_bf16 v[32:47], v[152:155], v[128:131], v[32:47]
    v_cvt_pk_bf16_f32 v132, v104, v105
    v_exp_f32 v109, v109
    v_exp_f32 v110, v110
    v_cvt_pk_bf16_f32 v133, v106, v107
    v_exp_f32 v111, v111
    v_exp_f32 v112, v112
    v_exp_f32 v113, v113
    v_cvt_pk_bf16_f32 v134, v108, v109
    v_exp_f32 v114, v114
    v_cvt_pk_bf16_f32 v135, v110, v111
    v_mfma_f32_32x32x16_bf16 v[96:111], v[148:151], v[24:27], 0
    v_exp_f32 v115, v115
    v_exp_f32 v116, v116
    v_cvt_pk_bf16_f32 v128, v112, v113
    v_mfma_f32_32x32x16_bf16 v[32:47], v[156:159], v[132:135], v[32:47]
    v_exp_f32 v117, v117
    v_exp_f32 v118, v118
    v_cvt_pk_bf16_f32 v129, v114, v115
    v_exp_f32 v119, v119
    v_exp_f32 v120, v120
    v_cvt_pk_bf16_f32 v130, v116, v117
    v_exp_f32 v121, v121
    v_exp_f32 v122, v122
    v_cvt_pk_bf16_f32 v131, v118, v119
    v_exp_f32 v123, v123
    v_exp_f32 v124, v124
    v_mfma_f32_32x32x16_bf16 v[48:63], v[152:155], v[128:131], v[48:63]
    v_cvt_pk_bf16_f32 v132, v120, v121
    v_exp_f32 v125, v125
    v_exp_f32 v126, v126
    v_cvt_pk_bf16_f32 v133, v122, v123
    v_exp_f32 v127, v127
    v_exp_f32 v96, v96
    v_exp_f32 v97, v97
    v_cvt_pk_bf16_f32 v134, v124, v125
    v_exp_f32 v98, v98
    v_cvt_pk_bf16_f32 v135, v126, v127
    v_mfma_f32_32x32x16_bf16 v[112:127], v[148:151], v[28:31], 0
    v_exp_f32 v99, v99
    v_exp_f32 v100, v100
    v_cvt_pk_bf16_f32 v128, v96, v97
    v_mfma_f32_32x32x16_bf16 v[48:63], v[156:159], v[132:135], v[48:63]
    v_exp_f32 v101, v101
    v_exp_f32 v102, v102
    v_cvt_pk_bf16_f32 v129, v98, v99
    v_exp_f32 v103, v103
    v_exp_f32 v104, v104
    v_cvt_pk_bf16_f32 v130, v100, v101
    v_exp_f32 v105, v105
    v_exp_f32 v106, v106
    v_cvt_pk_bf16_f32 v131, v102, v103
    v_exp_f32 v107, v107
    v_exp_f32 v108, v108
    v_mfma_f32_32x32x16_bf16 v[64:79], v[152:155], v[128:131], v[64:79]
    v_cvt_pk_bf16_f32 v132, v104, v105
    v_exp_f32 v109, v109
    v_exp_f32 v110, v110
    v_cvt_pk_bf16_f32 v133, v106, v107
    v_exp_f32 v111, v111
    v_exp_f32 v112, v112
    v_exp_f32 v113, v113
    v_cvt_pk_bf16_f32 v134, v108, v109
    v_exp_f32 v114, v114
    v_cvt_pk_bf16_f32 v135, v110, v111
    s_waitcnt vmcnt(2)
    v_mfma_f32_32x32x16_bf16 v[96:111], v[136:139], v[16:19], 0
    v_exp_f32 v115, v115
    v_exp_f32 v116, v116
    v_cvt_pk_bf16_f32 v128, v112, v113
    v_mfma_f32_32x32x16_bf16 v[64:79], v[156:159], v[132:135], v[64:79]
    v_exp_f32 v117, v117
    v_exp_f32 v118, v118
    v_cvt_pk_bf16_f32 v129, v114, v115
    v_exp_f32 v119, v119
    v_exp_f32 v120, v120
    v_cvt_pk_bf16_f32 v130, v116, v117
    v_exp_f32 v121, v121
    v_exp_f32 v122, v122
    v_cvt_pk_bf16_f32 v131, v118, v119
    v_exp_f32 v123, v123
    v_exp_f32 v124, v124
    v_mfma_f32_32x32x16_bf16 v[80:95], v[152:155], v[128:131], v[80:95]
    v_cvt_pk_bf16_f32 v132, v120, v121
    v_exp_f32 v125, v125
    v_exp_f32 v126, v126
    v_cvt_pk_bf16_f32 v133, v122, v123
    v_exp_f32 v127, v127
    s_add_u32 s40, s40, 2048
    s_add_u32 s41, s41, 4096
    v_exp_f32 v96, v96
    v_exp_f32 v97, v97
    v_cvt_pk_bf16_f32 v134, v124, v125
    v_exp_f32 v98, v98
    v_cvt_pk_bf16_f32 v135, v126, v127
    v_mfma_f32_32x32x16_bf16 v[112:127], v[136:139], v[20:23], 0
    v_exp_f32 v99, v99
    v_exp_f32 v100, v100
    v_cvt_pk_bf16_f32 v128, v96, v97
    v_mfma_f32_32x32x16_bf16 v[80:95], v[156:159], v[132:135], v[80:95]
    buffer_load_dwordx4 v[148:151], v1, s[4:7], s40 offen offset:0 sc1
    buffer_load_dwordx4 v[152:155], v1, s[4:7], s41 offen offset:0 sc1
    buffer_load_dwordx4 v[156:159], v1, s[4:7], s41 offen offset:1024 sc1
    buffer_load_dwordx4 a[40:43], v1, s[4:7], s43 offen offset:2048
    v_exp_f32 v101, v101
    v_exp_f32 v102, v102
    v_cvt_pk_bf16_f32 v129, v98, v99
    v_exp_f32 v103, v103
    v_exp_f32 v104, v104
    v_cvt_pk_bf16_f32 v130, v100, v101
    v_exp_f32 v105, v105
    v_exp_f32 v106, v106
    v_cvt_pk_bf16_f32 v131, v102, v103
    v_exp_f32 v107, v107
    v_exp_f32 v108, v108
    v_mfma_f32_32x32x16_bf16 v[32:47], v[140:143], v[128:131], v[32:47]
    v_cvt_pk_bf16_f32 v132, v104, v105
    v_exp_f32 v109, v109
    v_exp_f32 v110, v110
    v_cvt_pk_bf16_f32 v133, v106, v107
    v_exp_f32 v111, v111
    v_exp_f32 v112, v112
    v_exp_f32 v113, v113
    v_cvt_pk_bf16_f32 v134, v108, v109
    v_exp_f32 v114, v114
    v_cvt_pk_bf16_f32 v135, v110, v111
    v_mfma_f32_32x32x16_bf16 v[96:111], v[136:139], v[24:27], 0
    v_exp_f32 v115, v115
    v_exp_f32 v116, v116
    v_cvt_pk_bf16_f32 v128, v112, v113
    v_mfma_f32_32x32x16_bf16 v[32:47], v[144:147], v[132:135], v[32:47]
    v_exp_f32 v117, v117
    v_exp_f32 v118, v118
    v_cvt_pk_bf16_f32 v129, v114, v115
    v_exp_f32 v119, v119
    v_exp_f32 v120, v120
    v_cvt_pk_bf16_f32 v130, v116, v117
    v_exp_f32 v121, v121
    v_exp_f32 v122, v122
    v_cvt_pk_bf16_f32 v131, v118, v119
    v_exp_f32 v123, v123
    v_exp_f32 v124, v124
    v_mfma_f32_32x32x16_bf16 v[48:63], v[140:143], v[128:131], v[48:63]
    v_cvt_pk_bf16_f32 v132, v120, v121
    v_exp_f32 v125, v125
    v_exp_f32 v126, v126
    v_cvt_pk_bf16_f32 v133, v122, v123
    v_exp_f32 v127, v127
    v_exp_f32 v96, v96
    v_exp_f32 v97, v97
    v_cvt_pk_bf16_f32 v134, v124, v125
    v_exp_f32 v98, v98
    v_cvt_pk_bf16_f32 v135, v126, v127
    v_mfma_f32_32x32x16_bf16 v[112:127], v[136:139], v[28:31], 0
    v_exp_f32 v99, v99
    v_exp_f32 v100, v100
    v_cvt_pk_bf16_f32 v128, v96, v97
    v_mfma_f32_32x32x16_bf16 v[48:63], v[144:147], v[132:135], v[48:63]
    v_exp_f32 v101, v101
    v_exp_f32 v102, v102
    v_cvt_pk_bf16_f32 v129, v98, v99
    v_exp_f32 v103, v103
    v_exp_f32 v104, v104
    v_cvt_pk_bf16_f32 v130, v100, v101
    v_exp_f32 v105, v105
    v_exp_f32 v106, v106
    v_cvt_pk_bf16_f32 v131, v102, v103
    v_exp_f32 v107, v107
    v_exp_f32 v108, v108
    v_mfma_f32_32x32x16_bf16 v[64:79], v[140:143], v[128:131], v[64:79]
    v_cvt_pk_bf16_f32 v132, v104, v105
    v_exp_f32 v109, v109
    v_exp_f32 v110, v110
    v_cvt_pk_bf16_f32 v133, v106, v107
    v_exp_f32 v111, v111
    v_exp_f32 v112, v112
    v_exp_f32 v113, v113
    v_cvt_pk_bf16_f32 v134, v108, v109
    v_exp_f32 v114, v114
    v_cvt_pk_bf16_f32 v135, v110, v111
    s_waitcnt vmcnt(1)
    v_mfma_f32_32x32x16_bf16 v[96:111], v[148:151], v[16:19], 0
    v_exp_f32 v115, v115
    v_exp_f32 v116, v116
    v_cvt_pk_bf16_f32 v128, v112, v113
    v_mfma_f32_32x32x16_bf16 v[64:79], v[144:147], v[132:135], v[64:79]
    v_exp_f32 v117, v117
    v_exp_f32 v118, v118
    v_cvt_pk_bf16_f32 v129, v114, v115
    v_exp_f32 v119, v119
    v_exp_f32 v120, v120
    v_cvt_pk_bf16_f32 v130, v116, v117
    v_exp_f32 v121, v121
    v_exp_f32 v122, v122
    v_cvt_pk_bf16_f32 v131, v118, v119
    v_exp_f32 v123, v123
    v_exp_f32 v124, v124
    v_mfma_f32_32x32x16_bf16 v[80:95], v[140:143], v[128:131], v[80:95]
    v_cvt_pk_bf16_f32 v132, v120, v121
    v_exp_f32 v125, v125
    v_exp_f32 v126, v126
    v_cvt_pk_bf16_f32 v133, v122, v123
    v_exp_f32 v127, v127
    v_exp_f32 v96, v96
    v_exp_f32 v97, v97
    v_cvt_pk_bf16_f32 v134, v124, v125
    v_exp_f32 v98, v98
    v_cvt_pk_bf16_f32 v135, v126, v127
    v_mfma_f32_32x32x16_bf16 v[112:127], v[148:151], v[20:23], 0
    v_exp_f32 v99, v99
    v_exp_f32 v100, v100
    v_cvt_pk_bf16_f32 v128, v96, v97
    v_mfma_f32_32x32x16_bf16 v[80:95], v[144:147], v[132:135], v[80:95]
    buffer_load_dwordx4 v[136:139], v1, s[4:7], s40 offen offset:1024 sc1
    buffer_load_dwordx4 v[140:143], v1, s[4:7], s41 offen offset:2048 sc1
    buffer_load_dwordx4 v[144:147], v1, s[4:7], s41 offen offset:3072 sc1
    buffer_load_dwordx4 a[44:47], v1, s[4:7], s43 offen offset:3072
    s_add_u32 s53, s53, 8192
    s_and_b32 s53, s53, 0x7fff
    s_add_u32 s43, s52, s53
    v_exp_f32 v101, v101
    v_exp_f32 v102, v102
    v_cvt_pk_bf16_f32 v129, v98, v99
    v_exp_f32 v103, v103
    v_exp_f32 v104, v104
    v_cvt_pk_bf16_f32 v130, v100, v101
    v_exp_f32 v105, v105
    v_exp_f32 v106, v106
    v_cvt_pk_bf16_f32 v131, v102, v103
    v_exp_f32 v107, v107
    v_exp_f32 v108, v108
    v_mfma_f32_32x32x16_bf16 v[32:47], v[152:155], v[128:131], v[32:47]
    v_cvt_pk_bf16_f32 v132, v104, v105
    v_exp_f32 v109, v109
    v_exp_f32 v110, v110
    v_cvt_pk_bf16_f32 v133, v106, v107
    v_exp_f32 v111, v111
    v_exp_f32 v112, v112
    v_exp_f32 v113, v113
    v_cvt_pk_bf16_f32 v134, v108, v109
    v_exp_f32 v114, v114
    v_cvt_pk_bf16_f32 v135, v110, v111
    v_mfma_f32_32x32x16_bf16 v[96:111], v[148:151], v[24:27], 0
    v_exp_f32 v115, v115
    v_exp_f32 v116, v116
    v_cvt_pk_bf16_f32 v128, v112, v113
    v_mfma_f32_32x32x16_bf16 v[32:47], v[156:159], v[132:135], v[32:47]
    v_exp_f32 v117, v117
    v_exp_f32 v118, v118
    v_cvt_pk_bf16_f32 v129, v114, v115
    v_exp_f32 v119, v119
    v_exp_f32 v120, v120
    v_cvt_pk_bf16_f32 v130, v116, v117
    v_exp_f32 v121, v121
    v_exp_f32 v122, v122
    v_cvt_pk_bf16_f32 v131, v118, v119
    v_exp_f32 v123, v123
    v_exp_f32 v124, v124
    v_mfma_f32_32x32x16_bf16 v[48:63], v[152:155], v[128:131], v[48:63]
    v_cvt_pk_bf16_f32 v132, v120, v121
    v_exp_f32 v125, v125
    v_exp_f32 v126, v126
    v_cvt_pk_bf16_f32 v133, v122, v123
    v_exp_f32 v127, v127
    v_exp_f32 v96, v96
    v_exp_f32 v97, v97
    v_cvt_pk_bf16_f32 v134, v124, v125
    v_exp_f32 v98, v98
    v_cvt_pk_bf16_f32 v135, v126, v127
    v_mfma_f32_32x32x16_bf16 v[112:127], v[148:151], v[28:31], 0
    v_exp_f32 v99, v99
    v_exp_f32 v100, v100
    v_cvt_pk_bf16_f32 v128, v96, v97
    v_mfma_f32_32x32x16_bf16 v[48:63], v[156:159], v[132:135], v[48:63]
    v_exp_f32 v101, v101
    v_exp_f32 v102, v102
    v_cvt_pk_bf16_f32 v129, v98, v99
    v_exp_f32 v103, v103
    v_exp_f32 v104, v104
    v_cvt_pk_bf16_f32 v130, v100, v101
    v_exp_f32 v105, v105
    v_exp_f32 v106, v106
    v_cvt_pk_bf16_f32 v131, v102, v103
    v_exp_f32 v107, v107
    v_exp_f32 v108, v108
    v_mfma_f32_32x32x16_bf16 v[64:79], v[152:155], v[128:131], v[64:79]
    v_cvt_pk_bf16_f32 v132, v104, v105
    v_exp_f32 v109, v109
    v_exp_f32 v110, v110
    v_cvt_pk_bf16_f32 v133, v106, v107
    v_exp_f32 v111, v111
    v_exp_f32 v112, v112
    v_exp_f32 v113, v113
    v_cvt_pk_bf16_f32 v134, v108, v109
    v_exp_f32 v114, v114
    v_cvt_pk_bf16_f32 v135, v110, v111
    s_waitcnt vmcnt(1)
    v_mfma_f32_32x32x16_bf16 v[96:111], v[136:139], v[16:19], 0
    v_exp_f32 v115, v115
    v_exp_f32 v116, v116
    v_cvt_pk_bf16_f32 v128, v112, v113
    v_mfma_f32_32x32x16_bf16 v[64:79], v[156:159], v[132:135], v[64:79]
    v_exp_f32 v117, v117
    v_exp_f32 v118, v118
    v_cvt_pk_bf16_f32 v129, v114, v115
    v_exp_f32 v119, v119
    v_exp_f32 v120, v120
    v_cvt_pk_bf16_f32 v130, v116, v117
    v_exp_f32 v121, v121
    v_exp_f32 v122, v122
    v_cvt_pk_bf16_f32 v131, v118, v119
    v_exp_f32 v123, v123
    v_exp_f32 v124, v124
    v_mfma_f32_32x32x16_bf16 v[80:95], v[152:155], v[128:131], v[80:95]
    v_cvt_pk_bf16_f32 v132, v120, v121
    v_exp_f32 v125, v125
    v_exp_f32 v126, v126
    v_cvt_pk_bf16_f32 v133, v122, v123
    v_exp_f32 v127, v127
    s_add_u32 s40, s40, 2048
    s_add_u32 s41, s41, 4096
    v_exp_f32 v96, v96
    v_exp_f32 v97, v97
    v_cvt_pk_bf16_f32 v134, v124, v125
    v_exp_f32 v98, v98
    v_cvt_pk_bf16_f32 v135, v126, v127
    v_mfma_f32_32x32x16_bf16 v[112:127], v[136:139], v[20:23], 0
    v_exp_f32 v99, v99
    v_exp_f32 v100, v100
    v_cvt_pk_bf16_f32 v128, v96, v97
    v_mfma_f32_32x32x16_bf16 v[80:95], v[156:159], v[132:135], v[80:95]
    buffer_load_dwordx4 v[148:151], v1, s[4:7], s40 offen offset:0 sc1
    buffer_load_dwordx4 v[152:155], v1, s[4:7], s41 offen offset:0 sc1
    buffer_load_dwordx4 v[156:159], v1, s[4:7], s41 offen offset:1024 sc1
    buffer_load_dwordx4 a[48:51], v1, s[4:7], s43 offen offset:0
    v_exp_f32 v101, v101
    v_exp_f32 v102, v102
    v_cvt_pk_bf16_f32 v129, v98, v99
    v_exp_f32 v103, v103
    v_exp_f32 v104, v104
    v_cvt_pk_bf16_f32 v130, v100, v101
    v_exp_f32 v105, v105
    v_exp_f32 v106, v106
    v_cvt_pk_bf16_f32 v131, v102, v103
    v_exp_f32 v107, v107
    v_exp_f32 v108, v108
    v_mfma_f32_32x32x16_bf16 v[32:47], v[140:143], v[128:131], v[32:47]
    v_cvt_pk_bf16_f32 v132, v104, v105
    v_exp_f32 v109, v109
    v_exp_f32 v110, v110
    v_cvt_pk_bf16_f32 v133, v106, v107
    v_exp_f32 v111, v111
    v_exp_f32 v112, v112
    v_exp_f32 v113, v113
    v_cvt_pk_bf16_f32 v134, v108, v109
    v_exp_f32 v114, v114
    v_cvt_pk_bf16_f32 v135, v110, v111
    v_mfma_f32_32x32x16_bf16 v[96:111], v[136:139], v[24:27], 0
    v_exp_f32 v115, v115
    v_exp_f32 v116, v116
    v_cvt_pk_bf16_f32 v128, v112, v113
    v_mfma_f32_32x32x16_bf16 v[32:47], v[144:147], v[132:135], v[32:47]
    v_exp_f32 v117, v117
    v_exp_f32 v118, v118
    v_cvt_pk_bf16_f32 v129, v114, v115
    v_exp_f32 v119, v119
    v_exp_f32 v120, v120
    v_cvt_pk_bf16_f32 v130, v116, v117
    v_exp_f32 v121, v121
    v_exp_f32 v122, v122
    v_cvt_pk_bf16_f32 v131, v118, v119
    v_exp_f32 v123, v123
    v_exp_f32 v124, v124
    v_mfma_f32_32x32x16_bf16 v[48:63], v[140:143], v[128:131], v[48:63]
    v_cvt_pk_bf16_f32 v132, v120, v121
    v_exp_f32 v125, v125
    v_exp_f32 v126, v126
    v_cvt_pk_bf16_f32 v133, v122, v123
    v_exp_f32 v127, v127
    v_exp_f32 v96, v96
    v_exp_f32 v97, v97
    v_cvt_pk_bf16_f32 v134, v124, v125
    v_exp_f32 v98, v98
    v_cvt_pk_bf16_f32 v135, v126, v127
    v_mfma_f32_32x32x16_bf16 v[112:127], v[136:139], v[28:31], 0
    v_exp_f32 v99, v99
    v_exp_f32 v100, v100
    v_cvt_pk_bf16_f32 v128, v96, v97
    v_mfma_f32_32x32x16_bf16 v[48:63], v[144:147], v[132:135], v[48:63]
    v_exp_f32 v101, v101
    v_exp_f32 v102, v102
    v_cvt_pk_bf16_f32 v129, v98, v99
    v_exp_f32 v103, v103
    v_exp_f32 v104, v104
    v_cvt_pk_bf16_f32 v130, v100, v101
    v_exp_f32 v105, v105
    v_exp_f32 v106, v106
    v_cvt_pk_bf16_f32 v131, v102, v103
    v_exp_f32 v107, v107
    v_exp_f32 v108, v108
    v_mfma_f32_32x32x16_bf16 v[64:79], v[140:143], v[128:131], v[64:79]
    v_cvt_pk_bf16_f32 v132, v104, v105
    v_exp_f32 v109, v109
    v_exp_f32 v110, v110
    v_cvt_pk_bf16_f32 v133, v106, v107
    v_exp_f32 v111, v111
    v_exp_f32 v112, v112
    v_exp_f32 v113, v113
    v_cvt_pk_bf16_f32 v134, v108, v109
    v_exp_f32 v114, v114
    v_cvt_pk_bf16_f32 v135, v110, v111
    s_waitcnt vmcnt(1)
    v_mfma_f32_32x32x16_bf16 v[96:111], v[148:151], v[16:19], 0
    v_exp_f32 v115, v115
    v_exp_f32 v116, v116
    v_cvt_pk_bf16_f32 v128, v112, v113
    v_mfma_f32_32x32x16_bf16 v[64:79], v[144:147], v[132:135], v[64:79]
    v_exp_f32 v117, v117
    v_exp_f32 v118, v118
    v_cvt_pk_bf16_f32 v129, v114, v115
    v_exp_f32 v119, v119
    v_exp_f32 v120, v120
    v_cvt_pk_bf16_f32 v130, v116, v117
    v_exp_f32 v121, v121
    v_exp_f32 v122, v122
    v_cvt_pk_bf16_f32 v131, v118, v119
    v_exp_f32 v123, v123
    v_exp_f32 v124, v124
    v_mfma_f32_32x32x16_bf16 v[80:95], v[140:143], v[128:131], v[80:95]
    v_cvt_pk_bf16_f32 v132, v120, v121
    v_exp_f32 v125, v125
    v_exp_f32 v126, v126
    v_cvt_pk_bf16_f32 v133, v122, v123
    v_exp_f32 v127, v127
    v_exp_f32 v96, v96
    v_exp_f32 v97, v97
    v_cvt_pk_bf16_f32 v134, v124, v125
    v_exp_f32 v98, v98
    v_cvt_pk_bf16_f32 v135, v126, v127
    v_mfma_f32_32x32x16_bf16 v[112:127], v[148:151], v[20:23], 0
    v_exp_f32 v99, v99
    v_exp_f32 v100, v100
    v_cvt_pk_bf16_f32 v128, v96, v97
    v_mfma_f32_32x32x16_bf16 v[80:95], v[144:147], v[132:135], v[80:95]
    buffer_load_dwordx4 v[136:139], v1, s[4:7], s40 offen offset:1024 sc1
    buffer_load_dwordx4 v[140:143], v1, s[4:7], s41 offen offset:2048 sc1
    buffer_load_dwordx4 v[144:147], v1, s[4:7], s41 offen offset:3072 sc1
    buffer_load_dwordx4 a[52:55], v1, s[4:7], s43 offen offset:1024
    v_exp_f32 v101, v101
    v_exp_f32 v102, v102
    v_cvt_pk_bf16_f32 v129, v98, v99
    v_exp_f32 v103, v103
    v_exp_f32 v104, v104
    v_cvt_pk_bf16_f32 v130, v100, v101
    v_exp_f32 v105, v105
    v_exp_f32 v106, v106
    v_cvt_pk_bf16_f32 v131, v102, v103
    v_exp_f32 v107, v107
    v_exp_f32 v108, v108
    v_mfma_f32_32x32x16_bf16 v[32:47], v[152:155], v[128:131], v[32:47]
    v_cvt_pk_bf16_f32 v132, v104, v105
    v_exp_f32 v109, v109
    v_exp_f32 v110, v110
    v_cvt_pk_bf16_f32 v133, v106, v107
    v_exp_f32 v111, v111
    v_exp_f32 v112, v112
    v_exp_f32 v113, v113
    v_cvt_pk_bf16_f32 v134, v108, v109
    v_exp_f32 v114, v114
    v_cvt_pk_bf16_f32 v135, v110, v111
    v_mfma_f32_32x32x16_bf16 v[96:111], v[148:151], v[24:27], 0
    v_exp_f32 v115, v115
    v_exp_f32 v116, v116
    v_cvt_pk_bf16_f32 v128, v112, v113
    v_mfma_f32_32x32x16_bf16 v[32:47], v[156:159], v[132:135], v[32:47]
    v_exp_f32 v117, v117
    v_exp_f32 v118, v118
    v_cvt_pk_bf16_f32 v129, v114, v115
    v_exp_f32 v119, v119
    v_exp_f32 v120, v120
    v_cvt_pk_bf16_f32 v130, v116, v117
    v_exp_f32 v121, v121
    v_exp_f32 v122, v122
    v_cvt_pk_bf16_f32 v131, v118, v119
    v_exp_f32 v123, v123
    v_exp_f32 v124, v124
    v_mfma_f32_32x32x16_bf16 v[48:63], v[152:155], v[128:131], v[48:63]
    v_cvt_pk_bf16_f32 v132, v120, v121
    v_exp_f32 v125, v125
    v_exp_f32 v126, v126
    v_cvt_pk_bf16_f32 v133, v122, v123
    v_exp_f32 v127, v127
    v_exp_f32 v96, v96
    v_exp_f32 v97, v97
    v_cvt_pk_bf16_f32 v134, v124, v125
    v_exp_f32 v98, v98
    v_cvt_pk_bf16_f32 v135, v126, v127
    v_mfma_f32_32x32x16_bf16 v[112:127], v[148:151], v[28:31], 0
    v_exp_f32 v99, v99
    v_exp_f32 v100, v100
    v_cvt_pk_bf16_f32 v128, v96, v97
    v_mfma_f32_32x32x16_bf16 v[48:63], v[156:159], v[132:135], v[48:63]
    v_exp_f32 v101, v101
    v_exp_f32 v102, v102
    v_cvt_pk_bf16_f32 v129, v98, v99
    v_exp_f32 v103, v103
    v_exp_f32 v104, v104
    v_cvt_pk_bf16_f32 v130, v100, v101
    v_exp_f32 v105, v105
    v_exp_f32 v106, v106
    v_cvt_pk_bf16_f32 v131, v102, v103
    v_exp_f32 v107, v107
    v_exp_f32 v108, v108
    v_mfma_f32_32x32x16_bf16 v[64:79], v[152:155], v[128:131], v[64:79]
    v_cvt_pk_bf16_f32 v132, v104, v105
    v_exp_f32 v109, v109
    v_exp_f32 v110, v110
    v_cvt_pk_bf16_f32 v133, v106, v107
    v_exp_f32 v111, v111
    s_cmp_lt_u32 s3, 4
    s_cbranch_scc1 attn_kernel_loop1x
    s_setprio 0
attn_kernel_loop1x:
    v_exp_f32 v112, v112
    v_exp_f32 v113, v113
    v_cvt_pk_bf16_f32 v134, v108, v109
    v_exp_f32 v114, v114
    v_cvt_pk_bf16_f32 v135, v110, v111
    s_waitcnt vmcnt(1)
    v_mfma_f32_32x32x16_bf16 v[96:111], v[136:139], v[16:19], 0
    v_exp_f32 v115, v115
    v_exp_f32 v116, v116
    v_cvt_pk_bf16_f32 v128, v112, v113
    v_mfma_f32_32x32x16_bf16 v[64:79], v[156:159], v[132:135], v[64:79]
    v_exp_f32 v117, v117
    v_exp_f32 v118, v118
    v_cvt_pk_bf16_f32 v129, v114, v115
    v_exp_f32 v119, v119
    v_exp_f32 v120, v120
    v_cvt_pk_bf16_f32 v130, v116, v117
    v_exp_f32 v121, v121
    v_exp_f32 v122, v122
    v_cvt_pk_bf16_f32 v131, v118, v119
    v_exp_f32 v123, v123
    v_exp_f32 v124, v124
    v_mfma_f32_32x32x16_bf16 v[80:95], v[152:155], v[128:131], v[80:95]
    v_cvt_pk_bf16_f32 v132, v120, v121
    v_exp_f32 v125, v125
    v_exp_f32 v126, v126
    v_cvt_pk_bf16_f32 v133, v122, v123
    v_exp_f32 v127, v127
    s_add_u32 s40, s40, 2048
    s_add_u32 s41, s41, 4096
    v_exp_f32 v96, v96
    v_exp_f32 v97, v97
    v_cvt_pk_bf16_f32 v134, v124, v125
    v_exp_f32 v98, v98
    v_cvt_pk_bf16_f32 v135, v126, v127
    v_mfma_f32_32x32x16_bf16 v[112:127], v[136:139], v[20:23], 0
    v_exp_f32 v99, v99
    v_exp_f32 v100, v100
    v_cvt_pk_bf16_f32 v128, v96, v97
    v_mfma_f32_32x32x16_bf16 v[80:95], v[156:159], v[132:135], v[80:95]
    buffer_load_dwordx4 v[148:151], v1, s[4:7], s40 offen offset:0 sc1
    buffer_load_dwordx4 v[152:155], v1, s[4:7], s41 offen offset:0 sc1
    buffer_load_dwordx4 v[156:159], v1, s[4:7], s41 offen offset:1024 sc1
    buffer_load_dwordx4 a[56:59], v1, s[4:7], s43 offen offset:2048
    v_exp_f32 v101, v101
    v_exp_f32 v102, v102
    v_cvt_pk_bf16_f32 v129, v98, v99
    v_exp_f32 v103, v103
    v_exp_f32 v104, v104
    v_cvt_pk_bf16_f32 v130, v100, v101
    v_exp_f32 v105, v105
    v_exp_f32 v106, v106
    v_cvt_pk_bf16_f32 v131, v102, v103
    v_exp_f32 v107, v107
    v_exp_f32 v108, v108
    v_mfma_f32_32x32x16_bf16 v[32:47], v[140:143], v[128:131], v[32:47]
    v_cvt_pk_bf16_f32 v132, v104, v105
    v_exp_f32 v109, v109
    v_exp_f32 v110, v110
    v_cvt_pk_bf16_f32 v133, v106, v107
    v_exp_f32 v111, v111
    v_exp_f32 v112, v112
    v_exp_f32 v113, v113
    v_cvt_pk_bf16_f32 v134, v108, v109
    v_exp_f32 v114, v114
    v_cvt_pk_bf16_f32 v135, v110, v111
    v_mfma_f32_32x32x16_bf16 v[96:111], v[136:139], v[24:27], 0
    v_exp_f32 v115, v115
    v_exp_f32 v116, v116
    v_cvt_pk_bf16_f32 v128, v112, v113
    v_mfma_f32_32x32x16_bf16 v[32:47], v[144:147], v[132:135], v[32:47]
    v_exp_f32 v117, v117
    v_exp_f32 v118, v118
    v_cvt_pk_bf16_f32 v129, v114, v115
    v_exp_f32 v119, v119
    v_exp_f32 v120, v120
    v_cvt_pk_bf16_f32 v130, v116, v117
    v_exp_f32 v121, v121
    v_exp_f32 v122, v122
    v_cvt_pk_bf16_f32 v131, v118, v119
    v_exp_f32 v123, v123
    v_exp_f32 v124, v124
    v_mfma_f32_32x32x16_bf16 v[48:63], v[140:143], v[128:131], v[48:63]
    v_cvt_pk_bf16_f32 v132, v120, v121
    v_exp_f32 v125, v125
    v_exp_f32 v126, v126
    v_cvt_pk_bf16_f32 v133, v122, v123
    v_exp_f32 v127, v127
    v_exp_f32 v96, v96
    v_exp_f32 v97, v97
    v_cvt_pk_bf16_f32 v134, v124, v125
    v_exp_f32 v98, v98
    v_cvt_pk_bf16_f32 v135, v126, v127
    v_mfma_f32_32x32x16_bf16 v[112:127], v[136:139], v[28:31], 0
    v_exp_f32 v99, v99
    v_exp_f32 v100, v100
    v_cvt_pk_bf16_f32 v128, v96, v97
    v_mfma_f32_32x32x16_bf16 v[48:63], v[144:147], v[132:135], v[48:63]
    v_exp_f32 v101, v101
    v_exp_f32 v102, v102
    v_cvt_pk_bf16_f32 v129, v98, v99
    v_exp_f32 v103, v103
    v_exp_f32 v104, v104
    v_cvt_pk_bf16_f32 v130, v100, v101
    v_exp_f32 v105, v105
    v_exp_f32 v106, v106
    v_cvt_pk_bf16_f32 v131, v102, v103
    v_exp_f32 v107, v107
    v_exp_f32 v108, v108
    v_mfma_f32_32x32x16_bf16 v[64:79], v[140:143], v[128:131], v[64:79]
    v_cvt_pk_bf16_f32 v132, v104, v105
    v_exp_f32 v109, v109
    v_exp_f32 v110, v110
    v_cvt_pk_bf16_f32 v133, v106, v107
    v_exp_f32 v111, v111
    v_exp_f32 v112, v112
    v_exp_f32 v113, v113
    v_cvt_pk_bf16_f32 v134, v108, v109
    v_exp_f32 v114, v114
    v_cvt_pk_bf16_f32 v135, v110, v111
    s_waitcnt vmcnt(1)
    v_mfma_f32_32x32x16_bf16 v[96:111], v[148:151], v[16:19], 0
    v_exp_f32 v115, v115
    v_exp_f32 v116, v116
    v_cvt_pk_bf16_f32 v128, v112, v113
    v_mfma_f32_32x32x16_bf16 v[64:79], v[144:147], v[132:135], v[64:79]
    v_exp_f32 v117, v117
    v_exp_f32 v118, v118
    v_cvt_pk_bf16_f32 v129, v114, v115
    v_exp_f32 v119, v119
    v_exp_f32 v120, v120
    v_cvt_pk_bf16_f32 v130, v116, v117
    v_exp_f32 v121, v121
    v_exp_f32 v122, v122
    v_cvt_pk_bf16_f32 v131, v118, v119
    v_exp_f32 v123, v123
    v_exp_f32 v124, v124
    v_mfma_f32_32x32x16_bf16 v[80:95], v[140:143], v[128:131], v[80:95]
    v_cvt_pk_bf16_f32 v132, v120, v121
    v_exp_f32 v125, v125
    v_exp_f32 v126, v126
    v_cvt_pk_bf16_f32 v133, v122, v123
    v_exp_f32 v127, v127
    v_exp_f32 v96, v96
    v_exp_f32 v97, v97
    v_cvt_pk_bf16_f32 v134, v124, v125
    v_exp_f32 v98, v98
    v_cvt_pk_bf16_f32 v135, v126, v127
    v_mfma_f32_32x32x16_bf16 v[112:127], v[148:151], v[20:23], 0
    v_exp_f32 v99, v99
    v_exp_f32 v100, v100
    v_cvt_pk_bf16_f32 v128, v96, v97
    v_mfma_f32_32x32x16_bf16 v[80:95], v[144:147], v[132:135], v[80:95]
    buffer_load_dwordx4 a[60:63], v1, s[4:7], s43 offen offset:3072
    s_add_u32 s53, s53, 8192
    s_and_b32 s53, s53, 0x7fff
    s_add_u32 s43, s52, s53
    v_exp_f32 v101, v101
    v_exp_f32 v102, v102
    v_cvt_pk_bf16_f32 v129, v98, v99
    v_exp_f32 v103, v103
    v_exp_f32 v104, v104
    v_cvt_pk_bf16_f32 v130, v100, v101
    v_exp_f32 v105, v105
    v_exp_f32 v106, v106
    v_cvt_pk_bf16_f32 v131, v102, v103
    v_exp_f32 v107, v107
    v_exp_f32 v108, v108
    v_mfma_f32_32x32x16_bf16 v[32:47], v[152:155], v[128:131], v[32:47]
    v_cvt_pk_bf16_f32 v132, v104, v105
    v_exp_f32 v109, v109
    v_exp_f32 v110, v110
    v_cvt_pk_bf16_f32 v133, v106, v107
    v_exp_f32 v111, v111
    v_exp_f32 v112, v112
    v_exp_f32 v113, v113
    v_cvt_pk_bf16_f32 v134, v108, v109
    v_exp_f32 v114, v114
    v_cvt_pk_bf16_f32 v135, v110, v111
    v_mfma_f32_32x32x16_bf16 v[96:111], v[148:151], v[24:27], 0
    v_exp_f32 v115, v115
    v_exp_f32 v116, v116
    v_cvt_pk_bf16_f32 v128, v112, v113
    v_mfma_f32_32x32x16_bf16 v[32:47], v[156:159], v[132:135], v[32:47]
    v_exp_f32 v117, v117
    v_exp_f32 v118, v118
    v_cvt_pk_bf16_f32 v129, v114, v115
    v_exp_f32 v119, v119
    v_exp_f32 v120, v120
    v_cvt_pk_bf16_f32 v130, v116, v117
    v_exp_f32 v121, v121
    v_exp_f32 v122, v122
    v_cvt_pk_bf16_f32 v131, v118, v119
    v_exp_f32 v123, v123
    v_exp_f32 v124, v124
    v_mfma_f32_32x32x16_bf16 v[48:63], v[152:155], v[128:131], v[48:63]
    v_cvt_pk_bf16_f32 v132, v120, v121
    v_exp_f32 v125, v125
    v_exp_f32 v126, v126
    v_cvt_pk_bf16_f32 v133, v122, v123
    v_exp_f32 v127, v127
    v_exp_f32 v96, v96
    v_exp_f32 v97, v97
    v_cvt_pk_bf16_f32 v134, v124, v125
    v_exp_f32 v98, v98
    v_cvt_pk_bf16_f32 v135, v126, v127
    v_mfma_f32_32x32x16_bf16 v[112:127], v[148:151], v[28:31], 0
    v_exp_f32 v99, v99
    v_exp_f32 v100, v100
    v_cvt_pk_bf16_f32 v128, v96, v97
    v_mfma_f32_32x32x16_bf16 v[48:63], v[156:159], v[132:135], v[48:63]
    v_exp_f32 v101, v101
    v_exp_f32 v102, v102
    v_cvt_pk_bf16_f32 v129, v98, v99
    v_exp_f32 v103, v103
    v_exp_f32 v104, v104
    v_cvt_pk_bf16_f32 v130, v100, v101
    v_exp_f32 v105, v105
    v_exp_f32 v106, v106
    v_cvt_pk_bf16_f32 v131, v102, v103
    v_exp_f32 v107, v107
    v_exp_f32 v108, v108
    v_mfma_f32_32x32x16_bf16 v[64:79], v[152:155], v[128:131], v[64:79]
    v_cvt_pk_bf16_f32 v132, v104, v105
    v_exp_f32 v109, v109
    v_exp_f32 v110, v110
    v_cvt_pk_bf16_f32 v133, v106, v107
    v_exp_f32 v111, v111
    v_exp_f32 v112, v112
    v_exp_f32 v113, v113
    v_cvt_pk_bf16_f32 v134, v108, v109
    v_exp_f32 v114, v114
    v_cvt_pk_bf16_f32 v135, v110, v111
    v_exp_f32 v115, v115
    v_exp_f32 v116, v116
    v_cvt_pk_bf16_f32 v128, v112, v113
    v_mfma_f32_32x32x16_bf16 v[64:79], v[156:159], v[132:135], v[64:79]
    v_exp_f32 v117, v117
    v_exp_f32 v118, v118
    v_cvt_pk_bf16_f32 v129, v114, v115
    v_exp_f32 v119, v119
    v_exp_f32 v120, v120
    v_cvt_pk_bf16_f32 v130, v116, v117
    v_exp_f32 v121, v121
    v_exp_f32 v122, v122
    v_cvt_pk_bf16_f32 v131, v118, v119
    v_exp_f32 v123, v123
    v_exp_f32 v124, v124
    v_mfma_f32_32x32x16_bf16 v[80:95], v[152:155], v[128:131], v[80:95]
    v_cvt_pk_bf16_f32 v132, v120, v121
    v_exp_f32 v125, v125
    v_exp_f32 v126, v126
    v_cvt_pk_bf16_f32 v133, v122, v123
    v_exp_f32 v127, v127
    s_add_u32 s40, s40, 2048
    s_add_u32 s41, s41, 4096
    s_nop 0
    v_cvt_pk_bf16_f32 v134, v124, v125
    v_cvt_pk_bf16_f32 v135, v126, v127
    s_nop 1
    v_mfma_f32_32x32x16_bf16 v[80:95], v[156:159], v[132:135], v[80:95]
attn_kernel_fin:
    s_cmp_lt_u32 s3, 4
    s_cbranch_scc1 attn_kernel_fp
    s_setprio 2
attn_kernel_fp:
    s_lshl_b32 s18, s18, 2
    s_lshl_b32 s44, s16, 15
    s_lshl_b32 s45, s38, 11
    s_add_u32 s45, s45, s44
    s_add_u32 s46, s45, 3973120
    s_cmp_lg_u32 s39, 0
    s_cselect_b32 s46, 0x7ff00000, s46
    buffer_load_dwordx4 v[168:171], v1, s[4:7], s46 offen
    buffer_load_dwordx4 v[172:175], v1, s[4:7], s46 offen offset:1024
    s_add_u32 s44, s44, 10985472
    s_add_u32 s47, s22, s19
    s_lshl_b32 s47, s47, 10
    s_and_b32 s47, s47, 0x7fff
    s_nop 4
    s_xor_b32 s30, s19, 1
    s_add_u32 s30, s30, s18
    s_mul_i32 s30, s30, 6912
    v_add_u32 v6, s30, v1
    v_add_u32 v7, s30, v2
    ds_write_b128 v6, v[48:51] offset:0
    ds_write_b128 v6, v[52:55] offset:1024
    ds_write_b32 v7, v56 offset:2048
    s_xor_b32 s30, s19, 2
    s_add_u32 s30, s30, s18
    s_mul_i32 s30, s30, 6912
    v_add_u32 v6, s30, v1
    v_add_u32 v7, s30, v2
    ds_write_b128 v6, v[64:67] offset:2304
    ds_write_b128 v6, v[68:71] offset:3328
    ds_write_b32 v7, v72 offset:4352
    s_xor_b32 s30, s19, 3
    s_add_u32 s30, s30, s18
    s_mul_i32 s30, s30, 6912
    v_add_u32 v6, s30, v1
    v_add_u32 v7, s30, v2
    ds_write_b128 v6, v[80:83] offset:4608
    ds_write_b128 v6, v[84:87] offset:5632
    ds_write_b32 v7, v88 offset:6656
    s_add_u32 s30, s19, s18
    s_mul_i32 s30, s30, 6912
    v_add_u32 v6, s30, v1
    v_add_u32 v7, s30, v2
    s_waitcnt lgkmcnt(0)
    s_barrier
    ds_read_b128 v[48:51], v6 offset:0
    ds_read_b128 v[52:55], v6 offset:1024
    ds_read_b32 v56, v7 offset:2048
    ds_read_b128 v[64:67], v6 offset:2304
    ds_read_b128 v[68:71], v6 offset:3328
    ds_read_b32 v72, v7 offset:4352
    ds_read_b128 v[80:83], v6 offset:4608
    ds_read_b128 v[84:87], v6 offset:5632
    ds_read_b32 v88, v7 offset:6656
    s_waitcnt lgkmcnt(6)
    v_add_f32 v40, v40, v56
    v_add_f32 v32, v32, v48
    v_add_f32 v33, v33, v49
    v_add_f32 v34, v34, v50
    v_add_f32 v35, v35, v51
    v_add_f32 v36, v36, v52
    v_add_f32 v37, v37, v53
    v_add_f32 v38, v38, v54
    v_add_f32 v39, v39, v55
    s_waitcnt lgkmcnt(3)
    v_add_f32 v40, v40, v72
    v_add_f32 v32, v32, v64
    v_add_f32 v33, v33, v65
    v_add_f32 v34, v34, v66
    v_add_f32 v35, v35, v67
    v_add_f32 v36, v36, v68
    v_add_f32 v37, v37, v69
    v_add_f32 v38, v38, v70
    v_add_f32 v39, v39, v71
    s_waitcnt lgkmcnt(0)
    v_add_f32 v40, v40, v88
    v_add_f32 v32, v32, v80
    v_add_f32 v33, v33, v81
    v_add_f32 v34, v34, v82
    v_add_f32 v35, v35, v83
    v_add_f32 v36, v36, v84
    v_add_f32 v37, v37, v85
    v_add_f32 v38, v38, v86
    v_add_f32 v39, v39, v87
    v_rcp_f32 v40, v40
    s_add_u32 s24, s24, 2293760
    s_nop 0
    v_mul_f32 v32, v32, v40
    v_mul_f32 v33, v33, v40
    v_mul_f32 v34, v34, v40
    v_mul_f32 v35, v35, v40
    v_mul_f32 v36, v36, v40
    v_mul_f32 v37, v37, v40
    v_mul_f32 v38, v38, v40
    v_mul_f32 v39, v39, v40
    v_cvt_pk_bf16_f32 v128, v32, v33
    v_cvt_pk_bf16_f32 v129, v34, v35
    v_cvt_pk_bf16_f32 v130, v36, v37
    v_cvt_pk_bf16_f32 v131, v38, v39
    s_and_b32 s30, s47, 0x1fff
    s_add_u32 s30, s30, 55296
    v_add_u32 v8, s30, v1
    s_lshl_b32 s30, s39, 12
    s_add_u32 s30, s30, 55296
    v_add_u32 v10, s30, v1
    s_mov_b32 s34, 0x1000
    v_min_u32 v128, -2, v128
    v_min_u32 v129, -2, v129
    v_min_u32 v130, -2, v130
    v_min_u32 v131, -2, v131
    buffer_store_dwordx4 v[128:131], v1, s[4:7], s24 offen sc1
    ds_write_b128 v8, v[128:131]
    s_waitcnt vmcnt(1)
    v_lshlrev_b32 v32, 16, v168
    v_and_b32 v33, 0xffff0000, v168
    v_lshlrev_b32 v34, 16, v169
    v_and_b32 v35, 0xffff0000, v169
    v_lshlrev_b32 v36, 16, v170
    v_and_b32 v37, 0xffff0000, v170
    v_lshlrev_b32 v38, 16, v171
    v_and_b32 v39, 0xffff0000, v171
    v_lshlrev_b32 v40, 16, v172
    v_and_b32 v41, 0xffff0000, v172
    v_lshlrev_b32 v42, 16, v173
    v_and_b32 v43, 0xffff0000, v173
    v_lshlrev_b32 v44, 16, v174
    v_and_b32 v45, 0xffff0000, v174
    v_lshlrev_b32 v46, 16, v175
    v_and_b32 v47, 0xffff0000, v175
    s_waitcnt lgkmcnt(0)
    s_barrier
    ds_read_b128 v[96:99], v10 offset:0
    ds_read_b128 v[100:103], v10 offset:1024
    ds_read_b128 v[104:107], v10 offset:2048
    ds_read_b128 v[108:111], v10 offset:3072
    s_add_u32 s47, s47, 8192
    s_and_b32 s47, s47, 0x7fff
    s_add_u32 s48, s47, s44
    s_add_u32 s47, s47, 8192
    s_and_b32 s47, s47, 0x7fff
    s_add_u32 s49, s47, s44
    s_add_u32 s47, s47, 8192
    s_and_b32 s47, s47, 0x7fff
    s_add_u32 s50, s47, s44
    v_and_b32 v11, 31, v3
    v_lshrrev_b32 v9, 5, v3
    v_lshlrev_b32 v11, 4, v11
    v_lshl_add_u32 v11, v9, 2, v11
    s_and_b32 s30, s3, 3
    s_lshl_b32 s30, s30, 12
    v_add_u32 v9, s30, v1
    s_lshl_b32 s46, s16, 12
    s_bfe_u32 s47, s38, 0x20001
    s_lshl_b32 s47, s47, 10
    s_add_u32 s46, s46, s47
    s_lshr_b32 s47, s38, 3
    s_lshl_b32 s47, s47, 9
    s_add_u32 s46, s46, s47
    s_and_b32 s47, s38, 1
    s_lshl_b32 s47, s47, 3
    s_add_u32 s46, s46, s47
    s_add_u32 s46, s46, 8429568
    s_add_u32 s45, s45, 6070272
    s_waitcnt lgkmcnt(3)
    v_mfma_f32_32x32x16_bf16 v[32:47], a[0:3], v[96:99], v[32:47]
    s_waitcnt lgkmcnt(2)
    v_mfma_f32_32x32x16_bf16 v[32:47], a[4:7], v[100:103], v[32:47]
    s_waitcnt lgkmcnt(1)
    v_mfma_f32_32x32x16_bf16 v[32:47], a[8:11], v[104:107], v[32:47]
    s_waitcnt lgkmcnt(0)
    v_mfma_f32_32x32x16_bf16 v[32:47], a[12:15], v[108:111], v[32:47]
    s_waitcnt vmcnt(0)
attn_kernel_poll:
    buffer_load_dwordx4 v[16:19], v1, s[4:7], s48 offen sc1
    buffer_load_dwordx4 v[20:23], v1, s[4:7], s49 offen sc1
    buffer_load_dwordx4 v[24:27], v1, s[4:7], s50 offen sc1
    s_sub_u32 s34, s34, 1
    s_cbranch_scc1 attn_kernel_got
    s_waitcnt vmcnt(0)
    v_max3_u32 v6, v16, v17, v18
    v_max3_u32 v7, v19, v20, v21
    v_max3_u32 v6, v6, v22, v23
    v_max3_u32 v7, v7, v24, v25
    v_max3_u32 v6, v6, v26, v27
    v_max_u32 v6, v6, v7
    v_cmp_eq_u32 vcc, -1, v6
    s_nop 4
    s_cbranch_vccnz attn_kernel_poll
attn_kernel_got:
    s_waitcnt vmcnt(0)
    ds_write_b128 v8, v[16:19] offset:8192
    ds_write_b128 v8, v[20:23] offset:16384
    ds_write_b128 v8, v[24:27] offset:24576
    s_waitcnt lgkmcnt(0)
    s_barrier
    ds_read_b128 v[112:115], v10 offset:8192
    ds_read_b128 v[116:119], v10 offset:9216
    ds_read_b128 v[120:123], v10 offset:10240
    ds_read_b128 v[124:127], v10 offset:11264
    ds_read_b128 v[128:131], v10 offset:16384
    ds_read_b128 v[132:135], v10 offset:17408
    ds_read_b128 v[136:139], v10 offset:18432
    ds_read_b128 v[140:143], v10 offset:19456
    ds_read_b128 v[144:147], v10 offset:24576
    ds_read_b128 v[148:151], v10 offset:25600
    ds_read_b128 v[152:155], v10 offset:26624
    ds_read_b128 v[156:159], v10 offset:27648
    s_waitcnt lgkmcnt(11)
    v_mfma_f32_32x32x16_bf16 v[32:47], a[16:19], v[112:115], v[32:47]
    s_waitcnt lgkmcnt(10)
    v_mfma_f32_32x32x16_bf16 v[32:47], a[20:23], v[116:119], v[32:47]
    s_waitcnt lgkmcnt(9)
    v_mfma_f32_32x32x16_bf16 v[32:47], a[24:27], v[120:123], v[32:47]
    s_waitcnt lgkmcnt(8)
    v_mfma_f32_32x32x16_bf16 v[32:47], a[28:31], v[124:127], v[32:47]
    s_waitcnt lgkmcnt(7)
    v_mfma_f32_32x32x16_bf16 v[32:47], a[32:35], v[128:131], v[32:47]
    s_waitcnt lgkmcnt(6)
    v_mfma_f32_32x32x16_bf16 v[32:47], a[36:39], v[132:135], v[32:47]
    s_waitcnt lgkmcnt(5)
    v_mfma_f32_32x32x16_bf16 v[32:47], a[40:43], v[136:139], v[32:47]
    s_waitcnt lgkmcnt(4)
    v_mfma_f32_32x32x16_bf16 v[32:47], a[44:47], v[140:143], v[32:47]
    s_waitcnt lgkmcnt(3)
    v_mfma_f32_32x32x16_bf16 v[32:47], a[48:51], v[144:147], v[32:47]
    s_waitcnt lgkmcnt(2)
    v_mfma_f32_32x32x16_bf16 v[32:47], a[52:55], v[148:151], v[32:47]
    s_waitcnt lgkmcnt(1)
    v_mfma_f32_32x32x16_bf16 v[32:47], a[56:59], v[152:155], v[32:47]
    s_waitcnt lgkmcnt(0)
    v_mfma_f32_32x32x16_bf16 v[32:47], a[60:63], v[156:159], v[32:47]
    s_cmp_eq_u32 s39, 0
    s_cbranch_scc1 attn_kernel_red
    s_nop 15
    ds_write_b128 v9, v[32:35] offset:0
    ds_write_b128 v9, v[36:39] offset:1024
    ds_write_b128 v9, v[40:43] offset:2048
    ds_write_b128 v9, v[44:47] offset:3072
    s_waitcnt lgkmcnt(0)
    s_barrier
    s_endpgm
attn_kernel_red:
    s_lshl_b32 s58, s16, 11
    s_lshl_b32 s31, s38, 7
    s_add_u32 s58, s58, s31
    s_add_u32 s58, s58, s59
    s_add_u32 s58, s58, 8822784
    s_barrier
    ds_read_b128 v[48:51], v9 offset:0
    ds_read_b128 v[52:55], v9 offset:1024
    ds_read_b128 v[56:59], v9 offset:2048
    ds_read_b128 v[60:63], v9 offset:3072
    s_waitcnt lgkmcnt(3)
    v_add_f32 v32, v32, v48
    v_add_f32 v33, v33, v49
    v_add_f32 v34, v34, v50
    v_add_f32 v35, v35, v51
    s_waitcnt lgkmcnt(2)
    v_add_f32 v36, v36, v52
    v_add_f32 v37, v37, v53
    v_add_f32 v38, v38, v54
    v_add_f32 v39, v39, v55
    s_waitcnt lgkmcnt(1)
    v_add_f32 v40, v40, v56
    v_add_f32 v41, v41, v57
    v_add_f32 v42, v42, v58
    v_add_f32 v43, v43, v59
    s_waitcnt lgkmcnt(0)
    v_add_f32 v44, v44, v60
    v_add_f32 v45, v45, v61
    v_add_f32 v46, v46, v62
    v_add_f32 v47, v47, v63
    v_cvt_pk_bf16_f32 v128, v32, v33
    v_cvt_pk_bf16_f32 v129, v34, v35
    v_cvt_pk_bf16_f32 v130, v36, v37
    v_cvt_pk_bf16_f32 v131, v38, v39
    v_cvt_pk_bf16_f32 v132, v40, v41
    v_cvt_pk_bf16_f32 v133, v42, v43
    v_cvt_pk_bf16_f32 v134, v44, v45
    v_cvt_pk_bf16_f32 v135, v46, v47
    buffer_store_dwordx4 v[128:131], v1, s[4:7], s45 offen sc1
    buffer_store_dwordx4 v[132:135], v1, s[4:7], s45 offen offset:1024 sc1
    s_load_dwordx4 s[24:27], s[0:1], 72
    s_barrier
    v_add_f32 v12, v32, v33
    v_mul_f32 v13, v32, v32
    v_fma_f32 v13, v33, v33, v13
    v_add_f32 v12, v12, v34
    v_fma_f32 v13, v34, v34, v13
    v_add_f32 v12, v12, v35
    v_fma_f32 v13, v35, v35, v13
    v_add_f32 v12, v12, v36
    v_fma_f32 v13, v36, v36, v13
    v_add_f32 v12, v12, v37
    v_fma_f32 v13, v37, v37, v13
    v_add_f32 v12, v12, v38
    v_fma_f32 v13, v38, v38, v13
    v_add_f32 v12, v12, v39
    v_fma_f32 v13, v39, v39, v13
    v_add_f32 v12, v12, v40
    v_fma_f32 v13, v40, v40, v13
    v_add_f32 v12, v12, v41
    v_fma_f32 v13, v41, v41, v13
    v_add_f32 v12, v12, v42
    v_fma_f32 v13, v42, v42, v13
    v_add_f32 v12, v12, v43
    v_fma_f32 v13, v43, v43, v13
    v_add_f32 v12, v12, v44
    v_fma_f32 v13, v44, v44, v13
    v_add_f32 v12, v12, v45
    v_fma_f32 v13, v45, v45, v13
    v_add_f32 v12, v12, v46
    v_fma_f32 v13, v46, v46, v13
    v_add_f32 v12, v12, v47
    v_fma_f32 v13, v47, v47, v13
    s_nop 1
    v_permlane32_swap_b32 v12, v13
    s_nop 1
    v_add_f32 v12, v12, v13
    buffer_store_dword v12, v11, s[4:7], s46 offen sc1
    s_cmp_lt_u32 s2, 240
    s_cbranch_scc1 attn_kernel_f1
    v_mov_b32 v2, 0
    s_mov_b64 exec, 1
    s_waitcnt vmcnt(0)
    buffer_store_dword v2, v2, s[4:7], s58 offen sc1
    s_mov_b64 exec, -1
    s_branch attn_kernel_f2
attn_kernel_f1:
    v_lshrrev_b32 v2, 6, v0
    v_and_b32 v3, 63, v0
    v_readfirstlane_b32 s3, v2
    v_lshlrev_b32 v1, 4, v3
    v_lshrrev_b32 v4, 5, v3
    v_and_b32 v5, 31, v3
    s_and_b32 s16, s2, 7
    s_lshl_b32 s35, s3, 12
    s_lshl_b32 s36, s3, 10
    s_lshl_b32 s16, s16, 1
    s_bfe_u32 s18, s2, 0x10003
    s_add_u32 s16, s16, s18
    s_lshl_b32 s16, s16, 2
    s_add_u32 s16, s16, s3
    s_lshr_b32 s17, s2, 4
    s_lshl_b32 s18, s18, 2
    s_add_u32 s34, s17, s18
    s_and_b32 s34, s34, 7
    s_lshl_b32 s34, s34, 12
    s_mul_i32 s17, s17, 3
    s_lshl_b32 s40, s16, 15
    s_add_u32 s40, s40, 6070272
    s_lshl_b32 s41, s17, 15
    s_add_u32 s41, s41, s36
    s_add_u32 s41, s41, 524288
    v_mov_b32 v6, v1
    v_add_u32 v7, 36864, v1
    s_waitcnt lgkmcnt(0)
    s_mov_b32 s37, s34
    s_add_u32 s43, s41, s34
    s_add_u32 m0, s36, 0
    s_add_u32 s42, s43, 0
    buffer_load_dwordx4 v1, s[4:7], s42 offen lds
    s_add_u32 m0, s36, 4096
    s_add_u32 s42, s43, 32768
    buffer_load_dwordx4 v1, s[4:7], s42 offen lds
    s_add_u32 m0, s36, 8192
    s_add_u32 s42, s43, 65536
    buffer_load_dwordx4 v1, s[4:7], s42 offen lds
    s_add_u32 s34, s34, 4096
    s_and_b32 s34, s34, 0x7fff
    s_add_u32 s43, s41, s34
    s_add_u32 m0, s36, 12288
    s_add_u32 s42, s43, 0
    buffer_load_dwordx4 v1, s[4:7], s42 offen lds
    s_add_u32 m0, s36, 16384
    s_add_u32 s42, s43, 32768
    buffer_load_dwordx4 v1, s[4:7], s42 offen lds
    s_add_u32 m0, s36, 20480
    s_add_u32 s42, s43, 65536
    buffer_load_dwordx4 v1, s[4:7], s42 offen lds
    s_add_u32 s34, s34, 4096
    s_and_b32 s34, s34, 0x7fff
    s_add_u32 s43, s41, s34
    s_add_u32 m0, s36, 24576
    s_add_u32 s42, s43, 0
    buffer_load_dwordx4 v1, s[4:7], s42 offen lds
    s_add_u32 m0, s36, 28672
    s_add_u32 s42, s43, 32768
    buffer_load_dwordx4 v1, s[4:7], s42 offen lds
    s_add_u32 m0, s36, 32768
    s_add_u32 s42, s43, 65536
    buffer_load_dwordx4 v1, s[4:7], s42 offen lds
    s_add_u32 s34, s34, 4096
    s_and_b32 s34, s34, 0x7fff
    s_mov_b32 s34, s37
    v_mov_b32 v2, 0
    s_lshl_b32 s45, s16, 11
    s_add_u32 s45, s45, 8822784
    s_add_u32 s45, s45, s59
    s_mov_b32 s47, -1
    s_mov_b64 exec, 1
    s_waitcnt vmcnt(0)
    buffer_store_dword v2, v2, s[4:7], s58 offen sc1
    s_mov_b64 exec, -1
    s_nop 0
    v_lshlrev_b32 v2, 7, v3
    s_mov_b32 s46, 0x1000
    s_mov_b64 exec, 0xffff
    s_waitcnt vmcnt(0)
attn_kernel_fpl2:
    buffer_load_dword v10, v2, s[4:7], s45 offen sc1
    s_sub_u32 s46, s46, 1
    s_waitcnt vmcnt(0)
    s_cbranch_scc1 attn_kernel_fpg2
    v_cmp_ne_u32 vcc, 0, v10
    s_nop 4
    s_and_b32 s48, vcc_lo, s47
    s_cbranch_scc1 attn_kernel_fpl2
attn_kernel_fpg2:
    s_mov_b64 exec, -1
    s_add_u32 s42, s40, s34
    buffer_load_dwordx4 a[0:3], v1, s[4:7], s42 offen offset:0 sc1
    buffer_load_dwordx4 a[4:7], v1, s[4:7], s42 offen offset:1024 sc1
    buffer_load_dwordx4 a[8:11], v1, s[4:7], s42 offen offset:2048 sc1
    buffer_load_dwordx4 a[12:15], v1, s[4:7], s42 offen offset:3072 sc1
    s_add_u32 s34, s34, 4096
    s_and_b32 s34, s34, 0x7fff
    s_add_u32 s42, s40, s34
    buffer_load_dwordx4 a[16:19], v1, s[4:7], s42 offen offset:0 sc1
    buffer_load_dwordx4 a[20:23], v1, s[4:7], s42 offen offset:1024 sc1
    buffer_load_dwordx4 a[24:27], v1, s[4:7], s42 offen offset:2048 sc1
    buffer_load_dwordx4 a[28:31], v1, s[4:7], s42 offen offset:3072 sc1
    s_add_u32 s34, s34, 4096
    s_and_b32 s34, s34, 0x7fff
    s_add_u32 s42, s40, s34
    buffer_load_dwordx4 a[32:35], v1, s[4:7], s42 offen offset:0 sc1
    buffer_load_dwordx4 a[36:39], v1, s[4:7], s42 offen offset:1024 sc1
    buffer_load_dwordx4 a[40:43], v1, s[4:7], s42 offen offset:2048 sc1
    buffer_load_dwordx4 a[44:47], v1, s[4:7], s42 offen offset:3072 sc1
    s_add_u32 s34, s34, 4096
    s_and_b32 s34, s34, 0x7fff
    s_lshl_b32 s46, s16, 12
    s_add_u32 s46, s46, 8429568
    s_lshl_b32 s47, s17, 10
    s_add_u32 s47, s47, 1950720
    buffer_load_dwordx4 v[160:163], v1, s[4:7], s46 offen offset:0 sc1
    buffer_load_dwordx4 v[164:167], v1, s[4:7], s46 offen offset:1024 sc1
    buffer_load_dwordx4 v[168:171], v1, s[4:7], s46 offen offset:2048 sc1
    buffer_load_dwordx4 v[172:175], v1, s[4:7], s46 offen offset:3072 sc1
    buffer_load_dwordx4 v[176:179], v1, s[4:7], s47 offen offset:0 sc1
    buffer_load_dwordx4 v[180:183], v1, s[4:7], s47 offen offset:1024 sc1
    buffer_load_dwordx4 v[184:187], v1, s[4:7], s47 offen offset:2048 sc1
    s_mov_b32 s12, s20
    s_mov_b32 s13, s21
    s_mov_b32 s14, 3964928
    s_mov_b32 s15, 0x20000
    s_lshr_b32 s48, s2, 3
    s_lshl_b32 s48, s48, 12
    s_add_u32 s48, s48, s36
    s_add_u32 s48, s48, 1933312
    s_waitcnt vmcnt(15)
    s_barrier
    ds_read_b128 v[64:67], v6 offset:0
    ds_read_b128 v[80:83], v6 offset:4096
    ds_read_b128 v[96:99], v6 offset:8192
    ds_read_b128 v[68:71], v6 offset:1024
    ds_read_b128 v[84:87], v6 offset:5120
    ds_read_b128 v[100:103], v6 offset:9216
    ds_read_b128 v[72:75], v6 offset:2048
    ds_read_b128 v[88:91], v6 offset:6144
    ds_read_b128 v[104:107], v6 offset:10240
    ds_read_b128 v[76:79], v6 offset:3072
    ds_read_b128 v[92:95], v6 offset:7168
    ds_read_b128 v[108:111], v6 offset:11264
    s_add_u32 s43, s41, s34
    s_add_u32 m0, s36, 36864
    s_add_u32 s42, s43, 0
    buffer_load_dwordx4 v1, s[4:7], s42 offen lds
    s_add_u32 m0, s36, 40960
    s_add_u32 s42, s43, 32768
    buffer_load_dwordx4 v1, s[4:7], s42 offen lds
    s_add_u32 m0, s36, 45056
    s_add_u32 s42, s43, 65536
    buffer_load_dwordx4 v1, s[4:7], s42 offen lds
    s_add_u32 s42, s40, s34
    buffer_load_dwordx4 a[48:51], v1, s[4:7], s42 offen offset:0 sc1
    buffer_load_dwordx4 a[52:55], v1, s[4:7], s42 offen offset:1024 sc1
    buffer_load_dwordx4 a[56:59], v1, s[4:7], s42 offen offset:2048 sc1
    buffer_load_dwordx4 a[60:63], v1, s[4:7], s42 offen offset:3072 sc1
    s_add_u32 s34, s34, 4096
    s_and_b32 s34, s34, 0x7fff
    s_waitcnt vmcnt(18)
    s_barrier
    s_waitcnt lgkmcnt(9)
    v_mfma_f32_32x32x16_bf16 v[16:31], v[64:67], a[0:3], 0
    ds_read_b128 v[112:115], v6 offset:12288
    s_add_u32 s43, s41, s34
    s_add_u32 m0, s36, 49152
    s_add_u32 s42, s43, 0
    buffer_load_dwordx4 v1, s[4:7], s42 offen lds
    v_mfma_f32_32x32x16_bf16 v[32:47], v[80:83], a[0:3], 0
    ds_read_b128 v[128:131], v6 offset:16384
    s_add_u32 m0, s36, 53248
    s_add_u32 s42, s43, 32768
    buffer_load_dwordx4 v1, s[4:7], s42 offen lds
    v_mfma_f32_32x32x16_bf16 v[48:63], v[96:99], a[0:3], 0
    ds_read_b128 v[144:147], v6 offset:20480
    s_add_u32 m0, s36, 57344
    s_add_u32 s42, s43, 65536
    buffer_load_dwordx4 v1, s[4:7], s42 offen lds
    s_add_u32 s42, s40, s34
    buffer_load_dwordx4 a[0:3], v1, s[4:7], s42 offen offset:0 sc1
    s_waitcnt lgkmcnt(9)
    v_mfma_f32_32x32x16_bf16 v[16:31], v[68:71], a[4:7], v[16:31]
    ds_read_b128 v[116:119], v6 offset:13312
    v_mfma_f32_32x32x16_bf16 v[32:47], v[84:87], a[4:7], v[32:47]
    ds_read_b128 v[132:135], v6 offset:17408
    v_mfma_f32_32x32x16_bf16 v[48:63], v[100:103], a[4:7], v[48:63]
    ds_read_b128 v[148:151], v6 offset:21504
    buffer_load_dwordx4 a[4:7], v1, s[4:7], s42 offen offset:1024 sc1
    s_waitcnt lgkmcnt(9)
    v_mfma_f32_32x32x16_bf16 v[16:31], v[72:75], a[8:11], v[16:31]
    ds_read_b128 v[120:123], v6 offset:14336
    v_mfma_f32_32x32x16_bf16 v[32:47], v[88:91], a[8:11], v[32:47]
    ds_read_b128 v[136:139], v6 offset:18432
    v_mfma_f32_32x32x16_bf16 v[48:63], v[104:107], a[8:11], v[48:63]
    ds_read_b128 v[152:155], v6 offset:22528
    buffer_load_dwordx4 a[8:11], v1, s[4:7], s42 offen offset:2048 sc1
    s_waitcnt lgkmcnt(9)
    v_mfma_f32_32x32x16_bf16 v[16:31], v[76:79], a[12:15], v[16:31]
    ds_read_b128 v[124:127], v6 offset:15360
    v_mfma_f32_32x32x16_bf16 v[32:47], v[92:95], a[12:15], v[32:47]
    ds_read_b128 v[140:143], v6 offset:19456
    v_mfma_f32_32x32x16_bf16 v[48:63], v[108:111], a[12:15], v[48:63]
    ds_read_b128 v[156:159], v6 offset:23552
    buffer_load_dwordx4 a[12:15], v1, s[4:7], s42 offen offset:3072 sc1
    s_add_u32 s34, s34, 4096
    s_and_b32 s34, s34, 0x7fff
    s_waitcnt vmcnt(21)
    s_barrier
    s_waitcnt lgkmcnt(9)
    v_mfma_f32_32x32x16_bf16 v[16:31], v[112:115], a[16:19], v[16:31]
    ds_read_b128 v[64:67], v6 offset:24576
    s_add_u32 s43, s41, s34
    s_add_u32 m0, s36, 61440
    s_add_u32 s42, s43, 0
    buffer_load_dwordx4 v1, s[4:7], s42 offen lds
    v_mfma_f32_32x32x16_bf16 v[32:47], v[128:131], a[16:19], v[32:47]
    ds_read_b128 v[80:83], v6 offset:28672
    s_add_u32 m0, s36, 65536
    s_add_u32 s42, s43, 32768
    buffer_load_dwordx4 v1, s[4:7], s42 offen lds
    v_mfma_f32_32x32x16_bf16 v[48:63], v[144:147], a[16:19], v[48:63]
    ds_read_b128 v[96:99], v6 offset:32768
    s_add_u32 m0, s36, 69632
    s_add_u32 s42, s43, 65536
    buffer_load_dwordx4 v1, s[4:7], s42 offen lds
    s_add_u32 s42, s40, s34
    buffer_load_dwordx4 a[16:19], v1, s[4:7], s42 offen offset:0 sc1
    s_waitcnt lgkmcnt(9)
    v_mfma_f32_32x32x16_bf16 v[16:31], v[116:119], a[20:23], v[16:31]
    ds_read_b128 v[68:71], v6 offset:25600
    v_mfma_f32_32x32x16_bf16 v[32:47], v[132:135], a[20:23], v[32:47]
    ds_read_b128 v[84:87], v6 offset:29696
    v_mfma_f32_32x32x16_bf16 v[48:63], v[148:151], a[20:23], v[48:63]
    ds_read_b128 v[100:103], v6 offset:33792
    buffer_load_dwordx4 a[20:23], v1, s[4:7], s42 offen offset:1024 sc1
    s_waitcnt lgkmcnt(9)
    v_mfma_f32_32x32x16_bf16 v[16:31], v[120:123], a[24:27], v[16:31]
    ds_read_b128 v[72:75], v6 offset:26624
    v_mfma_f32_32x32x16_bf16 v[32:47], v[136:139], a[24:27], v[32:47]
    ds_read_b128 v[88:91], v6 offset:30720
    v_mfma_f32_32x32x16_bf16 v[48:63], v[152:155], a[24:27], v[48:63]
    ds_read_b128 v[104:107], v6 offset:34816
    buffer_load_dwordx4 a[24:27], v1, s[4:7], s42 offen offset:2048 sc1
    s_waitcnt lgkmcnt(9)
    v_mfma_f32_32x32x16_bf16 v[16:31], v[124:127], a[28:31], v[16:31]
    ds_read_b128 v[76:79], v6 offset:27648
    v_mfma_f32_32x32x16_bf16 v[32:47], v[140:143], a[28:31], v[32:47]
    ds_read_b128 v[92:95], v6 offset:31744
    v_mfma_f32_32x32x16_bf16 v[48:63], v[156:159], a[28:31], v[48:63]
    ds_read_b128 v[108:111], v6 offset:35840
    buffer_load_dwordx4 a[28:31], v1, s[4:7], s42 offen offset:3072 sc1
    s_add_u32 s34, s34, 4096
    s_and_b32 s34, s34, 0x7fff
    s_waitcnt vmcnt(14)
    s_barrier
    s_waitcnt lgkmcnt(9)
    v_mfma_f32_32x32x16_bf16 v[16:31], v[64:67], a[32:35], v[16:31]
    ds_read_b128 v[112:115], v7 offset:0
    s_add_u32 s43, s41, s34
    s_add_u32 m0, s36, 0
    s_add_u32 s42, s43, 0
    buffer_load_dwordx4 v1, s[4:7], s42 offen lds
    v_mfma_f32_32x32x16_bf16 v[32:47], v[80:83], a[32:35], v[32:47]
    ds_read_b128 v[128:131], v7 offset:4096
    s_add_u32 m0, s36, 4096
    s_add_u32 s42, s43, 32768
    buffer_load_dwordx4 v1, s[4:7], s42 offen lds
    v_mfma_f32_32x32x16_bf16 v[48:63], v[96:99], a[32:35], v[48:63]
    ds_read_b128 v[144:147], v7 offset:8192
    s_add_u32 m0, s36, 8192
    s_add_u32 s42, s43, 65536
    buffer_load_dwordx4 v1, s[4:7], s42 offen lds
    s_add_u32 s42, s40, s34
    buffer_load_dwordx4 a[32:35], v1, s[4:7], s42 offen offset:0 sc1
    s_waitcnt lgkmcnt(9)
    v_mfma_f32_32x32x16_bf16 v[16:31], v[68:71], a[36:39], v[16:31]
    ds_read_b128 v[116:119], v7 offset:1024
    v_mfma_f32_32x32x16_bf16 v[32:47], v[84:87], a[36:39], v[32:47]
    ds_read_b128 v[132:135], v7 offset:5120
    v_mfma_f32_32x32x16_bf16 v[48:63], v[100:103], a[36:39], v[48:63]
    ds_read_b128 v[148:151], v7 offset:9216
    buffer_load_dwordx4 a[36:39], v1, s[4:7], s42 offen offset:1024 sc1
    s_waitcnt lgkmcnt(9)
    v_mfma_f32_32x32x16_bf16 v[16:31], v[72:75], a[40:43], v[16:31]
    ds_read_b128 v[120:123], v7 offset:2048
    v_mfma_f32_32x32x16_bf16 v[32:47], v[88:91], a[40:43], v[32:47]
    ds_read_b128 v[136:139], v7 offset:6144
    v_mfma_f32_32x32x16_bf16 v[48:63], v[104:107], a[40:43], v[48:63]
    ds_read_b128 v[152:155], v7 offset:10240
    buffer_load_dwordx4 a[40:43], v1, s[4:7], s42 offen offset:2048 sc1
    s_waitcnt lgkmcnt(9)
    v_mfma_f32_32x32x16_bf16 v[16:31], v[76:79], a[44:47], v[16:31]
    ds_read_b128 v[124:127], v7 offset:3072
    v_mfma_f32_32x32x16_bf16 v[32:47], v[92:95], a[44:47], v[32:47]
    ds_read_b128 v[140:143], v7 offset:7168
    v_mfma_f32_32x32x16_bf16 v[48:63], v[108:111], a[44:47], v[48:63]
    ds_read_b128 v[156:159], v7 offset:11264
    buffer_load_dwordx4 a[44:47], v1, s[4:7], s42 offen offset:3072 sc1
    s_add_u32 s34, s34, 4096
    s_and_b32 s34, s34, 0x7fff
    s_waitcnt vmcnt(28)
    v_add_f32 v160, v160, v168
    v_add_f32 v161, v161, v169
    v_add_f32 v162, v162, v170
    v_add_f32 v163, v163, v171
    v_add_f32 v164, v164, v172
    v_add_f32 v165, v165, v173
    v_add_f32 v166, v166, v174
    v_add_f32 v167, v167, v175
    v_add_f32 v160, v160, v164
    v_add_f32 v161, v161, v165
    v_add_f32 v162, v162, v166
    v_add_f32 v163, v163, v167
    v_add_f32 v160, v160, v162
    v_add_f32 v161, v161, v163
    s_nop 1
    v_permlane32_swap_b32 v160, v161
    s_nop 1
    v_add_f32 v12, v160, v161
    v_add_f32 v13, v160, v161
    s_nop 1
    v_permlane32_swap_b32 v12, v13
    s_nop 1
    v_mul_f32 v10, 0x3b000000, v12
    v_mul_f32 v13, 0x3b000000, v13
    v_fma_f32 v13, -v10, v10, v13
    v_max_f32 v13, 0, v13
    v_add_f32 v13, 0x3727c5ac, v13
    v_rsq_f32 v11, v13
    s_nop 0
    v_mul_f32 v12, v13, v11
    v_cvt_pk_bf16_f32 v2, -v10, -v10
    v_cvt_pk_bf16_f32 v3, v12, v12
    v_cvt_pk_bf16_f32 v13, v11, v11
    v_and_b32 v2, 0xffff0000, v2
    v_and_b32 v3, 0xffff0000, v3
    v_and_b32 v13, 0xffff0000, v13
    v_sub_f32_e64 v2, -v10, v2
    v_sub_f32 v3, v12, v3
    v_sub_f32 v13, v11, v13
    v_cvt_pk_bf16_f32 v188, -v10, v2
    v_cvt_pk_bf16_f32 v189, -v10, v2
    v_cvt_pk_bf16_f32 v190, v12, v3
    v_cvt_pk_bf16_f32 v191, v11, v13
    s_nop 1
    v_mfma_f32_32x32x16_bf16 v[16:31], v[176:179], v[188:191], v[16:31]
    v_mfma_f32_32x32x16_bf16 v[32:47], v[180:183], v[188:191], v[32:47]
    v_mfma_f32_32x32x16_bf16 v[48:63], v[184:187], v[188:191], v[48:63]
    s_waitcnt vmcnt(14)
    s_barrier
    s_waitcnt lgkmcnt(9)
    v_mfma_f32_32x32x16_bf16 v[16:31], v[112:115], a[48:51], v[16:31]
    ds_read_b128 v[64:67], v7 offset:12288
    s_add_u32 s43, s41, s34
    s_add_u32 m0, s36, 12288
    s_add_u32 s42, s43, 0
    buffer_load_dwordx4 v1, s[4:7], s42 offen lds
    v_mfma_f32_32x32x16_bf16 v[32:47], v[128:131], a[48:51], v[32:47]
    ds_read_b128 v[80:83], v7 offset:16384
    s_add_u32 m0, s36, 16384
    s_add_u32 s42, s43, 32768
    buffer_load_dwordx4 v1, s[4:7], s42 offen lds
    v_mfma_f32_32x32x16_bf16 v[48:63], v[144:147], a[48:51], v[48:63]
    ds_read_b128 v[96:99], v7 offset:20480
    s_add_u32 m0, s36, 20480
    s_add_u32 s42, s43, 65536
    buffer_load_dwordx4 v1, s[4:7], s42 offen lds
    s_add_u32 s42, s40, s34
    buffer_load_dwordx4 a[48:51], v1, s[4:7], s42 offen offset:0 sc1
    s_waitcnt lgkmcnt(9)
    v_mfma_f32_32x32x16_bf16 v[16:31], v[116:119], a[52:55], v[16:31]
    ds_read_b128 v[68:71], v7 offset:13312
    v_mfma_f32_32x32x16_bf16 v[32:47], v[132:135], a[52:55], v[32:47]
    ds_read_b128 v[84:87], v7 offset:17408
    v_mfma_f32_32x32x16_bf16 v[48:63], v[148:151], a[52:55], v[48:63]
    ds_read_b128 v[100:103], v7 offset:21504
    buffer_load_dwordx4 a[52:55], v1, s[4:7], s42 offen offset:1024 sc1
    s_waitcnt lgkmcnt(9)
    v_mfma_f32_32x32x16_bf16 v[16:31], v[120:123], a[56:59], v[16:31]
    ds_read_b128 v[72:75], v7 offset:14336
    v_mfma_f32_32x32x16_bf16 v[32:47], v[136:139], a[56:59], v[32:47]
    ds_read_b128 v[88:91], v7 offset:18432
    v_mfma_f32_32x32x16_bf16 v[48:63], v[152:155], a[56:59], v[48:63]
    ds_read_b128 v[104:107], v7 offset:22528
    buffer_load_dwordx4 a[56:59], v1, s[4:7], s42 offen offset:2048 sc1
    s_waitcnt lgkmcnt(9)
    v_mfma_f32_32x32x16_bf16 v[16:31], v[124:127], a[60:63], v[16:31]
    ds_read_b128 v[76:79], v7 offset:15360
    v_mfma_f32_32x32x16_bf16 v[32:47], v[140:143], a[60:63], v[32:47]
    ds_read_b128 v[92:95], v7 offset:19456
    v_mfma_f32_32x32x16_bf16 v[48:63], v[156:159], a[60:63], v[48:63]
    ds_read_b128 v[108:111], v7 offset:23552
    buffer_load_dwordx4 a[60:63], v1, s[4:7], s42 offen offset:3072 sc1
    s_waitcnt vmcnt(14)
    s_barrier
    s_waitcnt lgkmcnt(9)
    v_mfma_f32_32x32x16_bf16 v[16:31], v[64:67], a[0:3], v[16:31]
    ds_read_b128 v[112:115], v7 offset:24576
    buffer_load_dwordx4 v[160:163], v1, s[12:15], s48 offen
    s_add_u32 s48, s48, 122880
    v_mfma_f32_32x32x16_bf16 v[32:47], v[80:83], a[0:3], v[32:47]
    ds_read_b128 v[128:131], v7 offset:28672
    buffer_load_dwordx4 v[160:163], v1, s[12:15], s48 offen
    s_add_u32 s48, s48, 122880
    v_mfma_f32_32x32x16_bf16 v[48:63], v[96:99], a[0:3], v[48:63]
    ds_read_b128 v[144:147], v7 offset:32768
    buffer_load_dwordx4 v[160:163], v1, s[12:15], s48 offen
    s_add_u32 s48, s48, 122880
    s_waitcnt lgkmcnt(9)
    v_mfma_f32_32x32x16_bf16 v[16:31], v[68:71], a[4:7], v[16:31]
    ds_read_b128 v[116:119], v7 offset:25600
    buffer_load_dwordx4 v[160:163], v1, s[12:15], s48 offen
    s_add_u32 s48, s48, 122880
    v_mfma_f32_32x32x16_bf16 v[32:47], v[84:87], a[4:7], v[32:47]
    ds_read_b128 v[132:135], v7 offset:29696
    buffer_load_dwordx4 v[160:163], v1, s[12:15], s48 offen
    s_add_u32 s48, s48, 122880
    v_mfma_f32_32x32x16_bf16 v[48:63], v[100:103], a[4:7], v[48:63]
    ds_read_b128 v[148:151], v7 offset:33792
    buffer_load_dwordx4 v[160:163], v1, s[12:15], s48 offen
    s_add_u32 s48, s48, 122880
    s_waitcnt lgkmcnt(9)
    v_mfma_f32_32x32x16_bf16 v[16:31], v[72:75], a[8:11], v[16:31]
    ds_read_b128 v[120:123], v7 offset:26624
    v_mfma_f32_32x32x16_bf16 v[32:47], v[88:91], a[8:11], v[32:47]
    ds_read_b128 v[136:139], v7 offset:30720
    v_mfma_f32_32x32x16_bf16 v[48:63], v[104:107], a[8:11], v[48:63]
    ds_read_b128 v[152:155], v7 offset:34816
    s_waitcnt lgkmcnt(9)
    v_mfma_f32_32x32x16_bf16 v[16:31], v[76:79], a[12:15], v[16:31]
    ds_read_b128 v[124:127], v7 offset:27648
    v_mfma_f32_32x32x16_bf16 v[32:47], v[92:95], a[12:15], v[32:47]
    ds_read_b128 v[140:143], v7 offset:31744
    v_mfma_f32_32x32x16_bf16 v[48:63], v[108:111], a[12:15], v[48:63]
    ds_read_b128 v[156:159], v7 offset:35840
    s_waitcnt vmcnt(13)
    s_barrier
    s_waitcnt lgkmcnt(9)
    v_mfma_f32_32x32x16_bf16 v[16:31], v[112:115], a[16:19], v[16:31]
    ds_read_b128 v[64:67], v6 offset:0
    buffer_load_dwordx4 v[160:163], v1, s[12:15], s48 offen
    s_add_u32 s48, s48, 122880
    v_mfma_f32_32x32x16_bf16 v[32:47], v[128:131], a[16:19], v[32:47]
    ds_read_b128 v[80:83], v6 offset:4096
    buffer_load_dwordx4 v[160:163], v1, s[12:15], s48 offen
    s_add_u32 s48, s48, 122880
    v_mfma_f32_32x32x16_bf16 v[48:63], v[144:147], a[16:19], v[48:63]
    ds_read_b128 v[96:99], v6 offset:8192
    buffer_load_dwordx4 v[160:163], v1, s[12:15], s48 offen
    s_add_u32 s48, s48, 122880
    s_waitcnt lgkmcnt(9)
    v_mfma_f32_32x32x16_bf16 v[16:31], v[116:119], a[20:23], v[16:31]
    ds_read_b128 v[68:71], v6 offset:1024
    buffer_load_dwordx4 v[160:163], v1, s[12:15], s48 offen
    s_add_u32 s48, s48, 122880
    v_mfma_f32_32x32x16_bf16 v[32:47], v[132:135], a[20:23], v[32:47]
    ds_read_b128 v[84:87], v6 offset:5120
    buffer_load_dwordx4 v[160:163], v1, s[12:15], s48 offen
    s_add_u32 s48, s48, 122880
    v_mfma_f32_32x32x16_bf16 v[48:63], v[148:151], a[20:23], v[48:63]
    ds_read_b128 v[100:103], v6 offset:9216
    buffer_load_dwordx4 v[160:163], v1, s[12:15], s48 offen
    s_add_u32 s48, s48, 122880
    s_waitcnt lgkmcnt(9)
    v_mfma_f32_32x32x16_bf16 v[16:31], v[120:123], a[24:27], v[16:31]
    ds_read_b128 v[72:75], v6 offset:2048
    v_mfma_f32_32x32x16_bf16 v[32:47], v[136:139], a[24:27], v[32:47]
    ds_read_b128 v[88:91], v6 offset:6144
    v_mfma_f32_32x32x16_bf16 v[48:63], v[152:155], a[24:27], v[48:63]
    ds_read_b128 v[104:107], v6 offset:10240
    s_waitcnt lgkmcnt(9)
    v_mfma_f32_32x32x16_bf16 v[16:31], v[124:127], a[28:31], v[16:31]
    ds_read_b128 v[76:79], v6 offset:3072
    v_mfma_f32_32x32x16_bf16 v[32:47], v[140:143], a[28:31], v[32:47]
    ds_read_b128 v[92:95], v6 offset:7168
    v_mfma_f32_32x32x16_bf16 v[48:63], v[156:159], a[28:31], v[48:63]
    ds_read_b128 v[108:111], v6 offset:11264
    s_waitcnt vmcnt(12)
    s_barrier
    s_waitcnt lgkmcnt(9)
    v_mfma_f32_32x32x16_bf16 v[16:31], v[64:67], a[32:35], v[16:31]
    ds_read_b128 v[112:115], v6 offset:12288
    buffer_load_dwordx4 v[160:163], v1, s[12:15], s48 offen
    s_add_u32 s48, s48, 122880
    v_mfma_f32_32x32x16_bf16 v[32:47], v[80:83], a[32:35], v[32:47]
    ds_read_b128 v[128:131], v6 offset:16384
    buffer_load_dwordx4 v[160:163], v1, s[12:15], s48 offen
    s_add_u32 s48, s48, 122880
    v_mfma_f32_32x32x16_bf16 v[48:63], v[96:99], a[32:35], v[48:63]
    ds_read_b128 v[144:147], v6 offset:20480
    buffer_load_dwordx4 v[160:163], v1, s[12:15], s48 offen
    s_add_u32 s48, s48, 122880
    s_waitcnt lgkmcnt(9)
    v_mfma_f32_32x32x16_bf16 v[16:31], v[68:71], a[36:39], v[16:31]
    ds_read_b128 v[116:119], v6 offset:13312
    buffer_load_dwordx4 v[160:163], v1, s[12:15], s48 offen
    s_add_u32 s48, s48, 122880
    v_mfma_f32_32x32x16_bf16 v[32:47], v[84:87], a[36:39], v[32:47]
    ds_read_b128 v[132:135], v6 offset:17408
    buffer_load_dwordx4 v[160:163], v1, s[12:15], s48 offen
    s_add_u32 s48, s48, 122880
    v_mfma_f32_32x32x16_bf16 v[48:63], v[100:103], a[36:39], v[48:63]
    ds_read_b128 v[148:151], v6 offset:21504
    buffer_load_dwordx4 v[160:163], v1, s[12:15], s48 offen
    s_add_u32 s48, s48, 122880
    s_waitcnt lgkmcnt(9)
    v_mfma_f32_32x32x16_bf16 v[16:31], v[72:75], a[40:43], v[16:31]
    ds_read_b128 v[120:123], v6 offset:14336
    v_mfma_f32_32x32x16_bf16 v[32:47], v[88:91], a[40:43], v[32:47]
    ds_read_b128 v[136:139], v6 offset:18432
    v_mfma_f32_32x32x16_bf16 v[48:63], v[104:107], a[40:43], v[48:63]
    ds_read_b128 v[152:155], v6 offset:22528
    s_waitcnt lgkmcnt(9)
    v_mfma_f32_32x32x16_bf16 v[16:31], v[76:79], a[44:47], v[16:31]
    ds_read_b128 v[124:127], v6 offset:15360
    v_mfma_f32_32x32x16_bf16 v[32:47], v[92:95], a[44:47], v[32:47]
    ds_read_b128 v[140:143], v6 offset:19456
    v_mfma_f32_32x32x16_bf16 v[48:63], v[108:111], a[44:47], v[48:63]
    ds_read_b128 v[156:159], v6 offset:23552
    s_waitcnt lgkmcnt(9)
    v_mfma_f32_32x32x16_bf16 v[16:31], v[112:115], a[48:51], v[16:31]
    v_mfma_f32_32x32x16_bf16 v[32:47], v[128:131], a[48:51], v[32:47]
    v_mfma_f32_32x32x16_bf16 v[48:63], v[144:147], a[48:51], v[48:63]
    s_waitcnt lgkmcnt(6)
    v_mfma_f32_32x32x16_bf16 v[16:31], v[116:119], a[52:55], v[16:31]
    v_mfma_f32_32x32x16_bf16 v[32:47], v[132:135], a[52:55], v[32:47]
    v_mfma_f32_32x32x16_bf16 v[48:63], v[148:151], a[52:55], v[48:63]
    s_waitcnt lgkmcnt(3)
    v_mfma_f32_32x32x16_bf16 v[16:31], v[120:123], a[56:59], v[16:31]
    v_mfma_f32_32x32x16_bf16 v[32:47], v[136:139], a[56:59], v[32:47]
    v_mfma_f32_32x32x16_bf16 v[48:63], v[152:155], a[56:59], v[48:63]
    s_waitcnt lgkmcnt(0)
    v_mfma_f32_32x32x16_bf16 v[16:31], v[124:127], a[60:63], v[16:31]
    v_mfma_f32_32x32x16_bf16 v[32:47], v[140:143], a[60:63], v[32:47]
    v_mfma_f32_32x32x16_bf16 v[48:63], v[156:159], a[60:63], v[48:63]
    s_barrier
    v_mov_b32 v13, v12
    v_mul_f32 v14, 0xc0135761, v11
    v_mul_f32 v2, v11, v11
    v_mul_f32 v8, 0x3d372713, v14
    v_mov_b32 v15, v14
    v_mul_f32 v8, v8, v2
    s_mul_i32 s49, s16, 86
    s_lshl_b32 s51, s17, 1
    s_add_u32 s49, s49, s51
    v_mov_b32 v9, v8
    s_lshl_b32 s49, s49, 10
    s_add_u32 s49, s49, 13082624
    s_add_u32 s50, s49, 2048
    s_add_u32 s51, s49, 4096
    s_cmp_eq_u32 s17, 42
    s_cselect_b32 s50, 0x7ff00000, s50
    s_cselect_b32 s51, 0x7ff00000, s51
    s_nop 7
    v_pk_mul_f32 v[64:65], v[16:17], v[16:17]
    v_pk_mul_f32 v[66:67], v[18:19], v[18:19]
    v_pk_mul_f32 v[68:69], v[20:21], v[20:21]
    v_pk_mul_f32 v[70:71], v[22:23], v[22:23]
    v_pk_fma_f32 v[64:65], v[64:65], v[8:9], v[14:15]
    v_pk_fma_f32 v[66:67], v[66:67], v[8:9], v[14:15]
    v_pk_fma_f32 v[68:69], v[68:69], v[8:9], v[14:15]
    v_pk_fma_f32 v[70:71], v[70:71], v[8:9], v[14:15]
    v_pk_mul_f32 v[64:65], v[16:17], v[64:65]
    v_pk_mul_f32 v[66:67], v[18:19], v[66:67]
    v_pk_mul_f32 v[68:69], v[20:21], v[68:69]
    v_pk_mul_f32 v[70:71], v[22:23], v[70:71]
    v_exp_f32 v64, v64
    v_exp_f32 v65, v65
    v_exp_f32 v66, v66
    v_exp_f32 v67, v67
    v_exp_f32 v68, v68
    v_exp_f32 v69, v69
    v_exp_f32 v70, v70
    v_exp_f32 v71, v71
    v_pk_fma_f32 v[64:65], v[64:65], v[12:13], v[12:13]
    v_pk_fma_f32 v[66:67], v[66:67], v[12:13], v[12:13]
    v_pk_fma_f32 v[68:69], v[68:69], v[12:13], v[12:13]
    v_pk_fma_f32 v[70:71], v[70:71], v[12:13], v[12:13]
    v_rcp_f32 v64, v64
    v_rcp_f32 v65, v65
    v_rcp_f32 v66, v66
    v_rcp_f32 v67, v67
    v_rcp_f32 v68, v68
    v_rcp_f32 v69, v69
    v_rcp_f32 v70, v70
    v_rcp_f32 v71, v71
    v_pk_mul_f32 v[64:65], v[16:17], v[64:65]
    v_pk_mul_f32 v[66:67], v[18:19], v[66:67]
    v_pk_mul_f32 v[68:69], v[20:21], v[68:69]
    v_pk_mul_f32 v[70:71], v[22:23], v[70:71]
    v_cvt_pk_bf16_f32 v96, v64, v65
    v_cvt_pk_bf16_f32 v97, v66, v67
    v_cvt_pk_bf16_f32 v98, v68, v69
    v_cvt_pk_bf16_f32 v99, v70, v71
    buffer_store_dwordx4 v[96:99], v1, s[4:7], s49 offen offset:0 sc1
    v_pk_mul_f32 v[80:81], v[24:25], v[24:25]
    v_pk_mul_f32 v[82:83], v[26:27], v[26:27]
    v_pk_mul_f32 v[84:85], v[28:29], v[28:29]
    v_pk_mul_f32 v[86:87], v[30:31], v[30:31]
    v_pk_fma_f32 v[80:81], v[80:81], v[8:9], v[14:15]
    v_pk_fma_f32 v[82:83], v[82:83], v[8:9], v[14:15]
    v_pk_fma_f32 v[84:85], v[84:85], v[8:9], v[14:15]
    v_pk_fma_f32 v[86:87], v[86:87], v[8:9], v[14:15]
    v_pk_mul_f32 v[80:81], v[24:25], v[80:81]
    v_pk_mul_f32 v[82:83], v[26:27], v[82:83]
    v_pk_mul_f32 v[84:85], v[28:29], v[84:85]
    v_pk_mul_f32 v[86:87], v[30:31], v[86:87]
    v_exp_f32 v80, v80
    v_exp_f32 v81, v81
    v_exp_f32 v82, v82
    v_exp_f32 v83, v83
    v_exp_f32 v84, v84
    v_exp_f32 v85, v85
    v_exp_f32 v86, v86
    v_exp_f32 v87, v87
    v_pk_fma_f32 v[80:81], v[80:81], v[12:13], v[12:13]
    v_pk_fma_f32 v[82:83], v[82:83], v[12:13], v[12:13]
    v_pk_fma_f32 v[84:85], v[84:85], v[12:13], v[12:13]
    v_pk_fma_f32 v[86:87], v[86:87], v[12:13], v[12:13]
    v_rcp_f32 v80, v80
    v_rcp_f32 v81, v81
    v_rcp_f32 v82, v82
    v_rcp_f32 v83, v83
    v_rcp_f32 v84, v84
    v_rcp_f32 v85, v85
    v_rcp_f32 v86, v86
    v_rcp_f32 v87, v87
    v_pk_mul_f32 v[80:81], v[24:25], v[80:81]
    v_pk_mul_f32 v[82:83], v[26:27], v[82:83]
    v_pk_mul_f32 v[84:85], v[28:29], v[84:85]
    v_pk_mul_f32 v[86:87], v[30:31], v[86:87]
    v_cvt_pk_bf16_f32 v100, v80, v81
    v_cvt_pk_bf16_f32 v101, v82, v83
    v_cvt_pk_bf16_f32 v102, v84, v85
    v_cvt_pk_bf16_f32 v103, v86, v87
    buffer_store_dwordx4 v[100:103], v1, s[4:7], s49 offen offset:1024 sc1
    v_pk_mul_f32 v[64:65], v[32:33], v[32:33]
    v_pk_mul_f32 v[66:67], v[34:35], v[34:35]
    v_pk_mul_f32 v[68:69], v[36:37], v[36:37]
    v_pk_mul_f32 v[70:71], v[38:39], v[38:39]
    v_pk_fma_f32 v[64:65], v[64:65], v[8:9], v[14:15]
    v_pk_fma_f32 v[66:67], v[66:67], v[8:9], v[14:15]
    v_pk_fma_f32 v[68:69], v[68:69], v[8:9], v[14:15]
    v_pk_fma_f32 v[70:71], v[70:71], v[8:9], v[14:15]
    v_pk_mul_f32 v[64:65], v[32:33], v[64:65]
    v_pk_mul_f32 v[66:67], v[34:35], v[66:67]
    v_pk_mul_f32 v[68:69], v[36:37], v[68:69]
    v_pk_mul_f32 v[70:71], v[38:39], v[70:71]
    v_exp_f32 v64, v64
    v_exp_f32 v65, v65
    v_exp_f32 v66, v66
    v_exp_f32 v67, v67
    v_exp_f32 v68, v68
    v_exp_f32 v69, v69
    v_exp_f32 v70, v70
    v_exp_f32 v71, v71
    v_pk_fma_f32 v[64:65], v[64:65], v[12:13], v[12:13]
    v_pk_fma_f32 v[66:67], v[66:67], v[12:13], v[12:13]
    v_pk_fma_f32 v[68:69], v[68:69], v[12:13], v[12:13]
    v_pk_fma_f32 v[70:71], v[70:71], v[12:13], v[12:13]
    v_rcp_f32 v64, v64
    v_rcp_f32 v65, v65
    v_rcp_f32 v66, v66
    v_rcp_f32 v67, v67
    v_rcp_f32 v68, v68
    v_rcp_f32 v69, v69
    v_rcp_f32 v70, v70
    v_rcp_f32 v71, v71
    v_pk_mul_f32 v[64:65], v[32:33], v[64:65]
    v_pk_mul_f32 v[66:67], v[34:35], v[66:67]
    v_pk_mul_f32 v[68:69], v[36:37], v[68:69]
    v_pk_mul_f32 v[70:71], v[38:39], v[70:71]
    v_cvt_pk_bf16_f32 v104, v64, v65
    v_cvt_pk_bf16_f32 v105, v66, v67
    v_cvt_pk_bf16_f32 v106, v68, v69
    v_cvt_pk_bf16_f32 v107, v70, v71
    buffer_store_dwordx4 v[104:107], v1, s[4:7], s50 offen offset:0 sc1
    v_pk_mul_f32 v[80:81], v[40:41], v[40:41]
    v_pk_mul_f32 v[82:83], v[42:43], v[42:43]
    v_pk_mul_f32 v[84:85], v[44:45], v[44:45]
    v_pk_mul_f32 v[86:87], v[46:47], v[46:47]
    v_pk_fma_f32 v[80:81], v[80:81], v[8:9], v[14:15]
    v_pk_fma_f32 v[82:83], v[82:83], v[8:9], v[14:15]
    v_pk_fma_f32 v[84:85], v[84:85], v[8:9], v[14:15]
    v_pk_fma_f32 v[86:87], v[86:87], v[8:9], v[14:15]
    v_pk_mul_f32 v[80:81], v[40:41], v[80:81]
    v_pk_mul_f32 v[82:83], v[42:43], v[82:83]
    v_pk_mul_f32 v[84:85], v[44:45], v[84:85]
    v_pk_mul_f32 v[86:87], v[46:47], v[86:87]
    v_exp_f32 v80, v80
    v_exp_f32 v81, v81
    v_exp_f32 v82, v82
    v_exp_f32 v83, v83
    v_exp_f32 v84, v84
    v_exp_f32 v85, v85
    v_exp_f32 v86, v86
    v_exp_f32 v87, v87
    v_pk_fma_f32 v[80:81], v[80:81], v[12:13], v[12:13]
    v_pk_fma_f32 v[82:83], v[82:83], v[12:13], v[12:13]
    v_pk_fma_f32 v[84:85], v[84:85], v[12:13], v[12:13]
    v_pk_fma_f32 v[86:87], v[86:87], v[12:13], v[12:13]
    v_rcp_f32 v80, v80
    v_rcp_f32 v81, v81
    v_rcp_f32 v82, v82
    v_rcp_f32 v83, v83
    v_rcp_f32 v84, v84
    v_rcp_f32 v85, v85
    v_rcp_f32 v86, v86
    v_rcp_f32 v87, v87
    v_pk_mul_f32 v[80:81], v[40:41], v[80:81]
    v_pk_mul_f32 v[82:83], v[42:43], v[82:83]
    v_pk_mul_f32 v[84:85], v[44:45], v[84:85]
    v_pk_mul_f32 v[86:87], v[46:47], v[86:87]
    v_cvt_pk_bf16_f32 v108, v80, v81
    v_cvt_pk_bf16_f32 v109, v82, v83
    v_cvt_pk_bf16_f32 v110, v84, v85
    v_cvt_pk_bf16_f32 v111, v86, v87
    buffer_store_dwordx4 v[108:111], v1, s[4:7], s50 offen offset:1024 sc1
    v_pk_mul_f32 v[64:65], v[48:49], v[48:49]
    v_pk_mul_f32 v[66:67], v[50:51], v[50:51]
    v_pk_mul_f32 v[68:69], v[52:53], v[52:53]
    v_pk_mul_f32 v[70:71], v[54:55], v[54:55]
    v_pk_fma_f32 v[64:65], v[64:65], v[8:9], v[14:15]
    v_pk_fma_f32 v[66:67], v[66:67], v[8:9], v[14:15]
    v_pk_fma_f32 v[68:69], v[68:69], v[8:9], v[14:15]
    v_pk_fma_f32 v[70:71], v[70:71], v[8:9], v[14:15]
    v_pk_mul_f32 v[64:65], v[48:49], v[64:65]
    v_pk_mul_f32 v[66:67], v[50:51], v[66:67]
    v_pk_mul_f32 v[68:69], v[52:53], v[68:69]
    v_pk_mul_f32 v[70:71], v[54:55], v[70:71]
    v_exp_f32 v64, v64
    v_exp_f32 v65, v65
    v_exp_f32 v66, v66
    v_exp_f32 v67, v67
    v_exp_f32 v68, v68
    v_exp_f32 v69, v69
    v_exp_f32 v70, v70
    v_exp_f32 v71, v71
    v_pk_fma_f32 v[64:65], v[64:65], v[12:13], v[12:13]
    v_pk_fma_f32 v[66:67], v[66:67], v[12:13], v[12:13]
    v_pk_fma_f32 v[68:69], v[68:69], v[12:13], v[12:13]
    v_pk_fma_f32 v[70:71], v[70:71], v[12:13], v[12:13]
    v_rcp_f32 v64, v64
    v_rcp_f32 v65, v65
    v_rcp_f32 v66, v66
    v_rcp_f32 v67, v67
    v_rcp_f32 v68, v68
    v_rcp_f32 v69, v69
    v_rcp_f32 v70, v70
    v_rcp_f32 v71, v71
    v_pk_mul_f32 v[64:65], v[48:49], v[64:65]
    v_pk_mul_f32 v[66:67], v[50:51], v[66:67]
    v_pk_mul_f32 v[68:69], v[52:53], v[68:69]
    v_pk_mul_f32 v[70:71], v[54:55], v[70:71]
    v_cvt_pk_bf16_f32 v112, v64, v65
    v_cvt_pk_bf16_f32 v113, v66, v67
    v_cvt_pk_bf16_f32 v114, v68, v69
    v_cvt_pk_bf16_f32 v115, v70, v71
    buffer_store_dwordx4 v[112:115], v1, s[4:7], s51 offen offset:0 sc1
    v_pk_mul_f32 v[80:81], v[56:57], v[56:57]
    v_pk_mul_f32 v[82:83], v[58:59], v[58:59]
    v_pk_mul_f32 v[84:85], v[60:61], v[60:61]
    v_pk_mul_f32 v[86:87], v[62:63], v[62:63]
    v_pk_fma_f32 v[80:81], v[80:81], v[8:9], v[14:15]
    v_pk_fma_f32 v[82:83], v[82:83], v[8:9], v[14:15]
    v_pk_fma_f32 v[84:85], v[84:85], v[8:9], v[14:15]
    v_pk_fma_f32 v[86:87], v[86:87], v[8:9], v[14:15]
    v_pk_mul_f32 v[80:81], v[56:57], v[80:81]
    v_pk_mul_f32 v[82:83], v[58:59], v[82:83]
    v_pk_mul_f32 v[84:85], v[60:61], v[84:85]
    v_pk_mul_f32 v[86:87], v[62:63], v[86:87]
    v_exp_f32 v80, v80
    v_exp_f32 v81, v81
    v_exp_f32 v82, v82
    v_exp_f32 v83, v83
    v_exp_f32 v84, v84
    v_exp_f32 v85, v85
    v_exp_f32 v86, v86
    v_exp_f32 v87, v87
    v_pk_fma_f32 v[80:81], v[80:81], v[12:13], v[12:13]
    v_pk_fma_f32 v[82:83], v[82:83], v[12:13], v[12:13]
    v_pk_fma_f32 v[84:85], v[84:85], v[12:13], v[12:13]
    v_pk_fma_f32 v[86:87], v[86:87], v[12:13], v[12:13]
    v_rcp_f32 v80, v80
    v_rcp_f32 v81, v81
    v_rcp_f32 v82, v82
    v_rcp_f32 v83, v83
    v_rcp_f32 v84, v84
    v_rcp_f32 v85, v85
    v_rcp_f32 v86, v86
    v_rcp_f32 v87, v87
    v_pk_mul_f32 v[80:81], v[56:57], v[80:81]
    v_pk_mul_f32 v[82:83], v[58:59], v[82:83]
    v_pk_mul_f32 v[84:85], v[60:61], v[84:85]
    v_pk_mul_f32 v[86:87], v[62:63], v[86:87]
    v_cvt_pk_bf16_f32 v116, v80, v81
    v_cvt_pk_bf16_f32 v117, v82, v83
    v_cvt_pk_bf16_f32 v118, v84, v85
    v_cvt_pk_bf16_f32 v119, v86, v87
    buffer_store_dwordx4 v[116:119], v1, s[4:7], s51 offen offset:1024 sc1
    s_lshr_b32 s49, s2, 4
    s_lshl_b32 s49, s49, 7
    s_lshl_b32 s50, s16, 11
    s_add_u32 s49, s49, s50
    s_add_u32 s49, s49, 8691712
    s_add_u32 s49, s49, s59
    v_mov_b32 v2, 0
    s_mov_b64 exec, 1
    s_waitcnt vmcnt(0)
    buffer_store_dword v2, v2, s[4:7], s49 offen sc1
    s_mov_b64 exec, -1
attn_kernel_f2:
    v_lshrrev_b32 v2, 6, v0
    v_and_b32 v3, 63, v0
    v_readfirstlane_b32 s3, v2
    v_lshlrev_b32 v1, 4, v3
    v_lshrrev_b32 v4, 5, v3
    v_and_b32 v5, 31, v3
    s_and_b32 s16, s2, 7
    s_lshl_b32 s35, s3, 12
    s_lshl_b32 s36, s3, 10
    s_lshr_b32 s19, s2, 3
    s_and_b32 s18, s19, 3
    s_lshl_b32 s16, s16, 2
    s_add_u32 s16, s16, s18
    s_lshr_b32 s17, s19, 2
    s_mul_i32 s34, s17, 21
    s_lshr_b32 s34, s34, 3
    s_mul_i32 s18, s18, 5
    s_add_u32 s34, s34, s18
    s_sub_u32 s18, s34, 21
    s_cmp_ge_u32 s34, 21
    s_cselect_b32 s34, s18, s34
    s_lshl_b32 s34, s34, 12
    s_and_b32 s18, s3, 1
    s_lshr_b32 s19, s3, 1
    s_mov_b32 s38, s17
    s_cmp_lt_u32 s3, 2
    s_cselect_b32 s40, s16, s17
    s_mov_b32 s41, 2555904
    s_cselect_b32 s41, 13082624, s41
    s_lshl_b32 s40, s40, 1
    s_add_u32 s40, s40, s18
    s_mul_i32 s40, s40, 88064
    s_add_u32 s40, s40, s41
    s_lshl_b32 s16, s16, 1
    s_add_u32 s16, s16, s18
    s_lshl_b32 s17, s17, 1
    s_add_u32 s17, s17, s19
    s_lshl_b32 s18, s18, 12
    s_lshl_b32 s19, s19, 12
    s_add_u32 s19, s19, 8192
    v_add_u32 v6, s18, v1
    v_add_u32 v8, s19, v1
    s_lshl_b32 s44, s16, 15
    s_lshl_b32 s45, s17, 11
    s_add_u32 s44, s44, s45
    s_waitcnt lgkmcnt(0)
    s_mov_b32 s8, s24
    s_mov_b32 s9, s25
    s_mov_b32 s10, 1024
    s_mov_b32 s11, 0x20000
    s_mov_b32 s12, s26
    s_mov_b32 s13, s27
    s_mov_b32 s14, 2097152
    s_mov_b32 s15, 0x20000
    v_add_u32 v7, 49152, v6
    v_add_u32 v9, 49152, v8
    s_mov_b64 vcc, 0
    s_cmp_ge_u32 s3, 2
    s_cbranch_scc1 attn_kernel_fnp
    s_lshl_b32 s45, s16, 11
    s_add_u32 s45, s45, 8691712
    s_add_u32 s45, s45, s59
    v_lshlrev_b32 v2, 7, v3
    s_lshr_b32 s47, s34, 12
    s_mul_i32 s47, s47, 43
    s_lshr_b32 s47, s47, 6
    s_lshl_b32 s47, 7, s47
    s_lshr_b32 s48, s47, 14
    s_or_b32 s47, s47, s48
    s_and_b32 s47, s47, 0x3fff
    s_mov_b32 s46, 0x1000
    s_mov_b64 exec, 0x7fff
    s_waitcnt vmcnt(0)
attn_kernel_fpl0:
    buffer_load_dword v10, v2, s[4:7], s45 offen sc1
    s_sub_u32 s46, s46, 1
    s_waitcnt vmcnt(0)
    s_cbranch_scc1 attn_kernel_fpg0
    v_cmp_ne_u32 vcc, 0, v10
    s_nop 4
    s_and_b32 s48, vcc_lo, s47
    s_cbranch_scc1 attn_kernel_fpl0
attn_kernel_fpg0:
    s_mov_b64 exec, -1
attn_kernel_fnp:
    s_add_u32 m0, s35, 0
    s_add_u32 s42, s40, s34
    buffer_load_dwordx4 v1, s[4:7], s42 offen offset:0 sc1 lds
    buffer_load_dwordx4 v1, s[4:7], s42 offen offset:1024 sc1 lds
    buffer_load_dwordx4 v1, s[4:7], s42 offen offset:2048 sc1 lds
    buffer_load_dwordx4 v1, s[4:7], s42 offen offset:3072 sc1 lds
    s_add_u32 s34, s34, 4096
    s_cmp_eq_u32 s34, 86016
    s_cselect_b32 s34, 0, s34
    s_add_u32 m0, s35, 16384
    s_add_u32 s42, s40, s34
    buffer_load_dwordx4 v1, s[4:7], s42 offen offset:0 sc1 lds
    buffer_load_dwordx4 v1, s[4:7], s42 offen offset:1024 sc1 lds
    buffer_load_dwordx4 v1, s[4:7], s42 offen offset:2048 sc1 lds
    buffer_load_dwordx4 v1, s[4:7], s42 offen offset:3072 sc1 lds
    s_add_u32 s34, s34, 4096
    s_cmp_eq_u32 s34, 86016
    s_cselect_b32 s34, 0, s34
    s_add_u32 m0, s35, 32768
    s_add_u32 s42, s40, s34
    buffer_load_dwordx4 v1, s[4:7], s42 offen offset:0 sc1 lds
    buffer_load_dwordx4 v1, s[4:7], s42 offen offset:1024 sc1 lds
    buffer_load_dwordx4 v1, s[4:7], s42 offen offset:2048 sc1 lds
    buffer_load_dwordx4 v1, s[4:7], s42 offen offset:3072 sc1 lds
    s_add_u32 s34, s34, 4096
    s_cmp_eq_u32 s34, 86016
    s_cselect_b32 s34, 0, s34
    s_cbranch_vccz attn_kernel_nq
    s_mov_b32 s47, -1
    s_mov_b32 s46, 0x1000
    s_mov_b64 exec, 0x7fff
attn_kernel_fpl1:
    buffer_load_dword v10, v2, s[4:7], s45 offen sc1
    s_sub_u32 s46, s46, 1
    s_waitcnt vmcnt(0)
    s_cbranch_scc1 attn_kernel_fpg1
    v_cmp_ne_u32 vcc, 0, v10
    s_nop 4
    s_and_b32 s48, vcc_lo, s47
    s_cbranch_scc1 attn_kernel_fpl1
attn_kernel_fpg1:
    s_mov_b64 exec, -1
attn_kernel_nq:
    s_waitcnt vmcnt(8)
    s_barrier
    ds_read_b128 v[48:51], v6 offset:0
    ds_read_b128 v[64:67], v8 offset:0
    ds_read_b128 v[52:55], v6 offset:1024
    ds_read_b128 v[68:71], v8 offset:1024
    ds_read_b128 v[56:59], v6 offset:2048
    ds_read_b128 v[72:75], v8 offset:2048
    ds_read_b128 v[60:63], v6 offset:3072
    ds_read_b128 v[76:79], v8 offset:3072
    s_add_u32 m0, s35, 49152
    s_add_u32 s42, s40, s34
    buffer_load_dwordx4 v1, s[4:7], s42 offen offset:0 sc1 lds
    buffer_load_dwordx4 v1, s[4:7], s42 offen offset:1024 sc1 lds
    buffer_load_dwordx4 v1, s[4:7], s42 offen offset:2048 sc1 lds
    buffer_load_dwordx4 v1, s[4:7], s42 offen offset:3072 sc1 lds
    s_add_u32 s34, s34, 4096
    s_cmp_eq_u32 s34, 86016
    s_cselect_b32 s34, 0, s34
    s_add_u32 s45, s44, 6070272
    buffer_load_dwordx4 v[160:163], v1, s[4:7], s45 offen offset:0 sc1
    buffer_load_dwordx4 v[164:167], v1, s[4:7], s45 offen offset:1024 sc1
    v_lshlrev_b32 v3, 3, v4
    s_lshl_b32 s47, s17, 6
    buffer_load_dwordx2 v[168:169], v3, s[8:11], s47 offen offset:0 sc1
    buffer_load_dwordx2 v[170:171], v3, s[8:11], s47 offen offset:16 sc1
    buffer_load_dwordx2 v[172:173], v3, s[8:11], s47 offen offset:32 sc1
    buffer_load_dwordx2 v[174:175], v3, s[8:11], s47 offen offset:48 sc1
    v_mov_b32 v112, -1
    v_mov_b32 v113, -1
    v_mov_b32 v114, -1
    v_mov_b32 v115, -1
    s_add_u32 s45, s44, 10985472
    s_cmp_lg_u32 s59, 0
    s_cselect_b32 s45, 0x7ff00000, s45
    buffer_store_dwordx4 v[112:115], v1, s[4:7], s45 offen offset:0 sc1
    buffer_store_dwordx4 v[112:115], v1, s[4:7], s45 offen offset:1024 sc1
    s_waitcnt vmcnt(16)
    s_barrier
    s_waitcnt lgkmcnt(6)
    v_mfma_f32_32x32x16_bf16 v[16:31], v[64:67], v[48:51], 0
    ds_read_b128 v[80:83], v6 offset:16384
    ds_read_b128 v[96:99], v8 offset:16384
    s_add_u32 m0, s35, 65536
    s_add_u32 s42, s40, s34
    buffer_load_dwordx4 v1, s[4:7], s42 offen offset:0 sc1 lds
    s_waitcnt lgkmcnt(6)
    v_mfma_f32_32x32x16_bf16 v[16:31], v[68:71], v[52:55], v[16:31]
    ds_read_b128 v[84:87], v6 offset:17408
    ds_read_b128 v[100:103], v8 offset:17408
    buffer_load_dwordx4 v1, s[4:7], s42 offen offset:1024 sc1 lds
    s_waitcnt lgkmcnt(6)
    v_mfma_f32_32x32x16_bf16 v[16:31], v[72:75], v[56:59], v[16:31]
    ds_read_b128 v[88:91], v6 offset:18432
    ds_read_b128 v[104:107], v8 offset:18432
    buffer_load_dwordx4 v1, s[4:7], s42 offen offset:2048 sc1 lds
    s_waitcnt lgkmcnt(6)
    v_mfma_f32_32x32x16_bf16 v[16:31], v[76:79], v[60:63], v[16:31]
    ds_read_b128 v[92:95], v6 offset:19456
    ds_read_b128 v[108:111], v8 offset:19456
    buffer_load_dwordx4 v1, s[4:7], s42 offen offset:3072 sc1 lds
    s_add_u32 s34, s34, 4096
    s_cmp_eq_u32 s34, 86016
    s_cselect_b32 s34, 0, s34
    s_waitcnt vmcnt(16)
    s_barrier
    s_waitcnt lgkmcnt(6)
    v_mfma_f32_32x32x16_bf16 v[16:31], v[96:99], v[80:83], v[16:31]
    ds_read_b128 v[48:51], v6 offset:32768
    ds_read_b128 v[64:67], v8 offset:32768
    s_add_u32 m0, s35, 81920
    s_add_u32 s42, s40, s34
    buffer_load_dwordx4 v1, s[4:7], s42 offen offset:0 sc1 lds
    s_waitcnt lgkmcnt(6)
    v_mfma_f32_32x32x16_bf16 v[16:31], v[100:103], v[84:87], v[16:31]
    ds_read_b128 v[52:55], v6 offset:33792
    ds_read_b128 v[68:71], v8 offset:33792
    buffer_load_dwordx4 v1, s[4:7], s42 offen offset:1024 sc1 lds
    s_waitcnt lgkmcnt(6)
    v_mfma_f32_32x32x16_bf16 v[16:31], v[104:107], v[88:91], v[16:31]
    ds_read_b128 v[56:59], v6 offset:34816
    ds_read_b128 v[72:75], v8 offset:34816
    buffer_load_dwordx4 v1, s[4:7], s42 offen offset:2048 sc1 lds
    s_waitcnt lgkmcnt(6)
    v_mfma_f32_32x32x16_bf16 v[16:31], v[108:111], v[92:95], v[16:31]
    ds_read_b128 v[60:63], v6 offset:35840
    ds_read_b128 v[76:79], v8 offset:35840
    buffer_load_dwordx4 v1, s[4:7], s42 offen offset:3072 sc1 lds
    s_add_u32 s34, s34, 4096
    s_cmp_eq_u32 s34, 86016
    s_cselect_b32 s34, 0, s34
    s_waitcnt vmcnt(16)
    s_barrier
    s_waitcnt lgkmcnt(6)
    v_mfma_f32_32x32x16_bf16 v[16:31], v[64:67], v[48:51], v[16:31]
    ds_read_b128 v[80:83], v7 offset:0
    ds_read_b128 v[96:99], v9 offset:0
    s_add_u32 m0, s35, 0
    s_add_u32 s42, s40, s34
    buffer_load_dwordx4 v1, s[4:7], s42 offen offset:0 sc1 lds
    s_waitcnt lgkmcnt(6)
    v_mfma_f32_32x32x16_bf16 v[16:31], v[68:71], v[52:55], v[16:31]
    ds_read_b128 v[84:87], v7 offset:1024
    ds_read_b128 v[100:103], v9 offset:1024
    buffer_load_dwordx4 v1, s[4:7], s42 offen offset:1024 sc1 lds
    s_waitcnt lgkmcnt(6)
    v_mfma_f32_32x32x16_bf16 v[16:31], v[72:75], v[56:59], v[16:31]
    ds_read_b128 v[88:91], v7 offset:2048
    ds_read_b128 v[104:107], v9 offset:2048
    buffer_load_dwordx4 v1, s[4:7], s42 offen offset:2048 sc1 lds
    s_waitcnt lgkmcnt(6)
    v_mfma_f32_32x32x16_bf16 v[16:31], v[76:79], v[60:63], v[16:31]
    ds_read_b128 v[92:95], v7 offset:3072
    ds_read_b128 v[108:111], v9 offset:3072
    buffer_load_dwordx4 v1, s[4:7], s42 offen offset:3072 sc1 lds
    s_add_u32 s34, s34, 4096
    s_cmp_eq_u32 s34, 86016
    s_cselect_b32 s34, 0, s34
    s_waitcnt vmcnt(14)
    v_lshlrev_b32 v176, 16, v160
    v_and_b32 v177, 0xffff0000, v160
    v_lshlrev_b32 v178, 16, v161
    v_and_b32 v179, 0xffff0000, v161
    v_lshlrev_b32 v180, 16, v162
    v_and_b32 v181, 0xffff0000, v162
    v_lshlrev_b32 v182, 16, v163
    v_and_b32 v183, 0xffff0000, v163
    v_lshlrev_b32 v184, 16, v164
    v_and_b32 v185, 0xffff0000, v164
    v_lshlrev_b32 v186, 16, v165
    v_and_b32 v187, 0xffff0000, v165
    v_lshlrev_b32 v188, 16, v166
    v_and_b32 v189, 0xffff0000, v166
    v_lshlrev_b32 v190, 16, v167
    v_and_b32 v191, 0xffff0000, v167
    v_lshlrev_b32 v2, 16, v168
    v_add_f32 v176, v176, v2
    v_and_b32 v3, 0xffff0000, v168
    v_add_f32 v177, v177, v3
    v_lshlrev_b32 v2, 16, v169
    v_add_f32 v178, v178, v2
    v_and_b32 v3, 0xffff0000, v169
    v_add_f32 v179, v179, v3
    v_lshlrev_b32 v2, 16, v170
    v_add_f32 v180, v180, v2
    v_and_b32 v3, 0xffff0000, v170
    v_add_f32 v181, v181, v3
    v_lshlrev_b32 v2, 16, v171
    v_add_f32 v182, v182, v2
    v_and_b32 v3, 0xffff0000, v171
    v_add_f32 v183, v183, v3
    v_lshlrev_b32 v2, 16, v172
    v_add_f32 v184, v184, v2
    v_and_b32 v3, 0xffff0000, v172
    v_add_f32 v185, v185, v3
    v_lshlrev_b32 v2, 16, v173
    v_add_f32 v186, v186, v2
    v_and_b32 v3, 0xffff0000, v173
    v_add_f32 v187, v187, v3
    v_lshlrev_b32 v2, 16, v174
    v_add_f32 v188, v188, v2
    v_and_b32 v3, 0xffff0000, v174
    v_add_f32 v189, v189, v3
    v_lshlrev_b32 v2, 16, v175
    v_add_f32 v190, v190, v2
    v_and_b32 v3, 0xffff0000, v175
    v_add_f32 v191, v191, v3
    s_waitcnt vmcnt(8)
    s_barrier
    s_waitcnt lgkmcnt(6)
    v_mfma_f32_32x32x16_bf16 v[16:31], v[96:99], v[80:83], v[16:31]
    ds_read_b128 v[48:51], v7 offset:16384
    ds_read_b128 v[64:67], v9 offset:16384
    s_add_u32 m0, s35, 16384
    s_add_u32 s42, s40, s34
    buffer_load_dwordx4 v1, s[4:7], s42 offen offset:0 sc1 lds
    s_waitcnt lgkmcnt(6)
    v_mfma_f32_32x32x16_bf16 v[16:31], v[100:103], v[84:87], v[16:31]
    ds_read_b128 v[52:55], v7 offset:17408
    ds_read_b128 v[68:71], v9 offset:17408
    buffer_load_dwordx4 v1, s[4:7], s42 offen offset:1024 sc1 lds
    s_waitcnt lgkmcnt(6)
    v_mfma_f32_32x32x16_bf16 v[16:31], v[104:107], v[88:91], v[16:31]
    ds_read_b128 v[56:59], v7 offset:18432
    ds_read_b128 v[72:75], v9 offset:18432
    buffer_load_dwordx4 v1, s[4:7], s42 offen offset:2048 sc1 lds
    s_waitcnt lgkmcnt(6)
    v_mfma_f32_32x32x16_bf16 v[16:31], v[108:111], v[92:95], v[16:31]
    ds_read_b128 v[60:63], v7 offset:19456
    ds_read_b128 v[76:79], v9 offset:19456
    buffer_load_dwordx4 v1, s[4:7], s42 offen offset:3072 sc1 lds
    s_add_u32 s34, s34, 4096
    s_cmp_eq_u32 s34, 86016
    s_cselect_b32 s34, 0, s34
    s_waitcnt vmcnt(8)
    s_barrier
    s_waitcnt lgkmcnt(6)
    v_mfma_f32_32x32x16_bf16 v[16:31], v[64:67], v[48:51], v[16:31]
    ds_read_b128 v[80:83], v7 offset:32768
    ds_read_b128 v[96:99], v9 offset:32768
    s_add_u32 m0, s35, 32768
    s_add_u32 s42, s40, s34
    buffer_load_dwordx4 v1, s[4:7], s42 offen offset:0 sc1 lds
    s_waitcnt lgkmcnt(6)
    v_mfma_f32_32x32x16_bf16 v[16:31], v[68:71], v[52:55], v[16:31]
    ds_read_b128 v[84:87], v7 offset:33792
    ds_read_b128 v[100:103], v9 offset:33792
    buffer_load_dwordx4 v1, s[4:7], s42 offen offset:1024 sc1 lds
    s_waitcnt lgkmcnt(6)
    v_mfma_f32_32x32x16_bf16 v[16:31], v[72:75], v[56:59], v[16:31]
    ds_read_b128 v[88:91], v7 offset:34816
    ds_read_b128 v[104:107], v9 offset:34816
    buffer_load_dwordx4 v1, s[4:7], s42 offen offset:2048 sc1 lds
    s_waitcnt lgkmcnt(6)
    v_mfma_f32_32x32x16_bf16 v[16:31], v[76:79], v[60:63], v[16:31]
    ds_read_b128 v[92:95], v7 offset:35840
    ds_read_b128 v[108:111], v9 offset:35840
    buffer_load_dwordx4 v1, s[4:7], s42 offen offset:3072 sc1 lds
    s_add_u32 s34, s34, 4096
    s_cmp_eq_u32 s34, 86016
    s_cselect_b32 s34, 0, s34
    s_waitcnt vmcnt(8)
    s_barrier
    s_waitcnt lgkmcnt(6)
    v_mfma_f32_32x32x16_bf16 v[16:31], v[96:99], v[80:83], v[16:31]
    ds_read_b128 v[48:51], v6 offset:0
    ds_read_b128 v[64:67], v8 offset:0
    s_add_u32 m0, s35, 49152
    s_add_u32 s42, s40, s34
    buffer_load_dwordx4 v1, s[4:7], s42 offen offset:0 sc1 lds
    s_waitcnt lgkmcnt(6)
    v_mfma_f32_32x32x16_bf16 v[16:31], v[100:103], v[84:87], v[16:31]
    ds_read_b128 v[52:55], v6 offset:1024
    ds_read_b128 v[68:71], v8 offset:1024
    buffer_load_dwordx4 v1, s[4:7], s42 offen offset:1024 sc1 lds
    s_waitcnt lgkmcnt(6)
    v_mfma_f32_32x32x16_bf16 v[16:31], v[104:107], v[88:91], v[16:31]
    ds_read_b128 v[56:59], v6 offset:2048
    ds_read_b128 v[72:75], v8 offset:2048
    buffer_load_dwordx4 v1, s[4:7], s42 offen offset:2048 sc1 lds
    s_waitcnt lgkmcnt(6)
    v_mfma_f32_32x32x16_bf16 v[16:31], v[108:111], v[92:95], v[16:31]
    ds_read_b128 v[60:63], v6 offset:3072
    ds_read_b128 v[76:79], v8 offset:3072
    buffer_load_dwordx4 v1, s[4:7], s42 offen offset:3072 sc1 lds
    s_add_u32 s34, s34, 4096
    s_cmp_eq_u32 s34, 86016
    s_cselect_b32 s34, 0, s34
    s_waitcnt vmcnt(8)
    s_barrier
    s_waitcnt lgkmcnt(6)
    v_mfma_f32_32x32x16_bf16 v[16:31], v[64:67], v[48:51], v[16:31]
    ds_read_b128 v[80:83], v6 offset:16384
    ds_read_b128 v[96:99], v8 offset:16384
    s_add_u32 m0, s35, 65536
    s_add_u32 s42, s40, s34
    buffer_load_dwordx4 v1, s[4:7], s42 offen offset:0 sc1 lds
    s_waitcnt lgkmcnt(6)
    v_mfma_f32_32x32x16_bf16 v[16:31], v[68:71], v[52:55], v[16:31]
    ds_read_b128 v[84:87], v6 offset:17408
    ds_read_b128 v[100:103], v8 offset:17408
    buffer_load_dwordx4 v1, s[4:7], s42 offen offset:1024 sc1 lds
    s_waitcnt lgkmcnt(6)
    v_mfma_f32_32x32x16_bf16 v[16:31], v[72:75], v[56:59], v[16:31]
    ds_read_b128 v[88:91], v6 offset:18432
    ds_read_b128 v[104:107], v8 offset:18432
    buffer_load_dwordx4 v1, s[4:7], s42 offen offset:2048 sc1 lds
    s_waitcnt lgkmcnt(6)
    v_mfma_f32_32x32x16_bf16 v[16:31], v[76:79], v[60:63], v[16:31]
    ds_read_b128 v[92:95], v6 offset:19456
    ds_read_b128 v[108:111], v8 offset:19456
    buffer_load_dwordx4 v1, s[4:7], s42 offen offset:3072 sc1 lds
    s_add_u32 s34, s34, 4096
    s_cmp_eq_u32 s34, 86016
    s_cselect_b32 s34, 0, s34
    s_waitcnt vmcnt(8)
    s_barrier
    s_waitcnt lgkmcnt(6)
    v_mfma_f32_32x32x16_bf16 v[16:31], v[96:99], v[80:83], v[16:31]
    ds_read_b128 v[48:51], v6 offset:32768
    ds_read_b128 v[64:67], v8 offset:32768
    s_add_u32 m0, s35, 81920
    s_add_u32 s42, s40, s34
    buffer_load_dwordx4 v1, s[4:7], s42 offen offset:0 sc1 lds
    s_waitcnt lgkmcnt(6)
    v_mfma_f32_32x32x16_bf16 v[16:31], v[100:103], v[84:87], v[16:31]
    ds_read_b128 v[52:55], v6 offset:33792
    ds_read_b128 v[68:71], v8 offset:33792
    buffer_load_dwordx4 v1, s[4:7], s42 offen offset:1024 sc1 lds
    s_waitcnt lgkmcnt(6)
    v_mfma_f32_32x32x16_bf16 v[16:31], v[104:107], v[88:91], v[16:31]
    ds_read_b128 v[56:59], v6 offset:34816
    ds_read_b128 v[72:75], v8 offset:34816
    buffer_load_dwordx4 v1, s[4:7], s42 offen offset:2048 sc1 lds
    s_waitcnt lgkmcnt(6)
    v_mfma_f32_32x32x16_bf16 v[16:31], v[108:111], v[92:95], v[16:31]
    ds_read_b128 v[60:63], v6 offset:35840
    ds_read_b128 v[76:79], v8 offset:35840
    buffer_load_dwordx4 v1, s[4:7], s42 offen offset:3072 sc1 lds
    s_add_u32 s34, s34, 4096
    s_cmp_eq_u32 s34, 86016
    s_cselect_b32 s34, 0, s34
    s_waitcnt vmcnt(8)
    s_barrier
    s_waitcnt lgkmcnt(6)
    v_mfma_f32_32x32x16_bf16 v[16:31], v[64:67], v[48:51], v[16:31]
    ds_read_b128 v[80:83], v7 offset:0
    ds_read_b128 v[96:99], v9 offset:0
    s_add_u32 m0, s35, 0
    s_add_u32 s42, s40, s34
    buffer_load_dwordx4 v1, s[4:7], s42 offen offset:0 sc1 lds
    s_waitcnt lgkmcnt(6)
    v_mfma_f32_32x32x16_bf16 v[16:31], v[68:71], v[52:55], v[16:31]
    ds_read_b128 v[84:87], v7 offset:1024
    ds_read_b128 v[100:103], v9 offset:1024
    buffer_load_dwordx4 v1, s[4:7], s42 offen offset:1024 sc1 lds
    s_waitcnt lgkmcnt(6)
    v_mfma_f32_32x32x16_bf16 v[16:31], v[72:75], v[56:59], v[16:31]
    ds_read_b128 v[88:91], v7 offset:2048
    ds_read_b128 v[104:107], v9 offset:2048
    buffer_load_dwordx4 v1, s[4:7], s42 offen offset:2048 sc1 lds
    s_waitcnt lgkmcnt(6)
    v_mfma_f32_32x32x16_bf16 v[16:31], v[76:79], v[60:63], v[16:31]
    ds_read_b128 v[92:95], v7 offset:3072
    ds_read_b128 v[108:111], v9 offset:3072
    buffer_load_dwordx4 v1, s[4:7], s42 offen offset:3072 sc1 lds
    s_add_u32 s34, s34, 4096
    s_cmp_eq_u32 s34, 86016
    s_cselect_b32 s34, 0, s34
    s_waitcnt vmcnt(8)
    s_barrier
    s_waitcnt lgkmcnt(6)
    v_mfma_f32_32x32x16_bf16 v[16:31], v[96:99], v[80:83], v[16:31]
    ds_read_b128 v[48:51], v7 offset:16384
    ds_read_b128 v[64:67], v9 offset:16384
    s_add_u32 m0, s35, 16384
    s_add_u32 s42, s40, s34
    buffer_load_dwordx4 v1, s[4:7], s42 offen offset:0 sc1 lds
    s_waitcnt lgkmcnt(6)
    v_mfma_f32_32x32x16_bf16 v[16:31], v[100:103], v[84:87], v[16:31]
    ds_read_b128 v[52:55], v7 offset:17408
    ds_read_b128 v[68:71], v9 offset:17408
    buffer_load_dwordx4 v1, s[4:7], s42 offen offset:1024 sc1 lds
    s_waitcnt lgkmcnt(6)
    v_mfma_f32_32x32x16_bf16 v[16:31], v[104:107], v[88:91], v[16:31]
    ds_read_b128 v[56:59], v7 offset:18432
    ds_read_b128 v[72:75], v9 offset:18432
    buffer_load_dwordx4 v1, s[4:7], s42 offen offset:2048 sc1 lds
    s_waitcnt lgkmcnt(6)
    v_mfma_f32_32x32x16_bf16 v[16:31], v[108:111], v[92:95], v[16:31]
    ds_read_b128 v[60:63], v7 offset:19456
    ds_read_b128 v[76:79], v9 offset:19456
    buffer_load_dwordx4 v1, s[4:7], s42 offen offset:3072 sc1 lds
    s_add_u32 s34, s34, 4096
    s_cmp_eq_u32 s34, 86016
    s_cselect_b32 s34, 0, s34
    s_waitcnt vmcnt(8)
    s_barrier
    s_waitcnt lgkmcnt(6)
    v_mfma_f32_32x32x16_bf16 v[16:31], v[64:67], v[48:51], v[16:31]
    ds_read_b128 v[80:83], v7 offset:32768
    ds_read_b128 v[96:99], v9 offset:32768
    s_add_u32 m0, s35, 32768
    s_add_u32 s42, s40, s34
    buffer_load_dwordx4 v1, s[4:7], s42 offen offset:0 sc1 lds
    s_waitcnt lgkmcnt(6)
    v_mfma_f32_32x32x16_bf16 v[16:31], v[68:71], v[52:55], v[16:31]
    ds_read_b128 v[84:87], v7 offset:33792
    ds_read_b128 v[100:103], v9 offset:33792
    buffer_load_dwordx4 v1, s[4:7], s42 offen offset:1024 sc1 lds
    s_waitcnt lgkmcnt(6)
    v_mfma_f32_32x32x16_bf16 v[16:31], v[72:75], v[56:59], v[16:31]
    ds_read_b128 v[88:91], v7 offset:34816
    ds_read_b128 v[104:107], v9 offset:34816
    buffer_load_dwordx4 v1, s[4:7], s42 offen offset:2048 sc1 lds
    s_waitcnt lgkmcnt(6)
    v_mfma_f32_32x32x16_bf16 v[16:31], v[76:79], v[60:63], v[16:31]
    ds_read_b128 v[92:95], v7 offset:35840
    ds_read_b128 v[108:111], v9 offset:35840
    buffer_load_dwordx4 v1, s[4:7], s42 offen offset:3072 sc1 lds
    s_add_u32 s34, s34, 4096
    s_cmp_eq_u32 s34, 86016
    s_cselect_b32 s34, 0, s34
    s_waitcnt vmcnt(8)
    s_barrier
    s_waitcnt lgkmcnt(6)
    v_mfma_f32_32x32x16_bf16 v[16:31], v[96:99], v[80:83], v[16:31]
    ds_read_b128 v[48:51], v6 offset:0
    ds_read_b128 v[64:67], v8 offset:0
    s_add_u32 m0, s35, 49152
    s_add_u32 s42, s40, s34
    buffer_load_dwordx4 v1, s[4:7], s42 offen offset:0 sc1 lds
    s_waitcnt lgkmcnt(6)
    v_mfma_f32_32x32x16_bf16 v[16:31], v[100:103], v[84:87], v[16:31]
    ds_read_b128 v[52:55], v6 offset:1024
    ds_read_b128 v[68:71], v8 offset:1024
    buffer_load_dwordx4 v1, s[4:7], s42 offen offset:1024 sc1 lds
    s_waitcnt lgkmcnt(6)
    v_mfma_f32_32x32x16_bf16 v[16:31], v[104:107], v[88:91], v[16:31]
    ds_read_b128 v[56:59], v6 offset:2048
    ds_read_b128 v[72:75], v8 offset:2048
    buffer_load_dwordx4 v1, s[4:7], s42 offen offset:2048 sc1 lds
    s_waitcnt lgkmcnt(6)
    v_mfma_f32_32x32x16_bf16 v[16:31], v[108:111], v[92:95], v[16:31]
    ds_read_b128 v[60:63], v6 offset:3072
    ds_read_b128 v[76:79], v8 offset:3072
    buffer_load_dwordx4 v1, s[4:7], s42 offen offset:3072 sc1 lds
    s_add_u32 s34, s34, 4096
    s_cmp_eq_u32 s34, 86016
    s_cselect_b32 s34, 0, s34
    s_waitcnt vmcnt(8)
    s_barrier
    s_waitcnt lgkmcnt(6)
    v_mfma_f32_32x32x16_bf16 v[16:31], v[64:67], v[48:51], v[16:31]
    ds_read_b128 v[80:83], v6 offset:16384
    ds_read_b128 v[96:99], v8 offset:16384
    s_add_u32 m0, s35, 65536
    s_add_u32 s42, s40, s34
    buffer_load_dwordx4 v1, s[4:7], s42 offen offset:0 sc1 lds
    s_waitcnt lgkmcnt(6)
    v_mfma_f32_32x32x16_bf16 v[16:31], v[68:71], v[52:55], v[16:31]
    ds_read_b128 v[84:87], v6 offset:17408
    ds_read_b128 v[100:103], v8 offset:17408
    buffer_load_dwordx4 v1, s[4:7], s42 offen offset:1024 sc1 lds
    s_waitcnt lgkmcnt(6)
    v_mfma_f32_32x32x16_bf16 v[16:31], v[72:75], v[56:59], v[16:31]
    ds_read_b128 v[88:91], v6 offset:18432
    ds_read_b128 v[104:107], v8 offset:18432
    buffer_load_dwordx4 v1, s[4:7], s42 offen offset:2048 sc1 lds
    s_waitcnt lgkmcnt(6)
    v_mfma_f32_32x32x16_bf16 v[16:31], v[76:79], v[60:63], v[16:31]
    ds_read_b128 v[92:95], v6 offset:19456
    ds_read_b128 v[108:111], v8 offset:19456
    buffer_load_dwordx4 v1, s[4:7], s42 offen offset:3072 sc1 lds
    s_add_u32 s34, s34, 4096
    s_cmp_eq_u32 s34, 86016
    s_cselect_b32 s34, 0, s34
    s_waitcnt vmcnt(8)
    s_barrier
    s_waitcnt lgkmcnt(6)
    v_mfma_f32_32x32x16_bf16 v[16:31], v[96:99], v[80:83], v[16:31]
    ds_read_b128 v[48:51], v6 offset:32768
    ds_read_b128 v[64:67], v8 offset:32768
    s_add_u32 m0, s35, 81920
    s_add_u32 s42, s40, s34
    buffer_load_dwordx4 v1, s[4:7], s42 offen offset:0 sc1 lds
    s_waitcnt lgkmcnt(6)
    v_mfma_f32_32x32x16_bf16 v[16:31], v[100:103], v[84:87], v[16:31]
    ds_read_b128 v[52:55], v6 offset:33792
    ds_read_b128 v[68:71], v8 offset:33792
    buffer_load_dwordx4 v1, s[4:7], s42 offen offset:1024 sc1 lds
    s_waitcnt lgkmcnt(6)
    v_mfma_f32_32x32x16_bf16 v[16:31], v[104:107], v[88:91], v[16:31]
    ds_read_b128 v[56:59], v6 offset:34816
    ds_read_b128 v[72:75], v8 offset:34816
    buffer_load_dwordx4 v1, s[4:7], s42 offen offset:2048 sc1 lds
    s_waitcnt lgkmcnt(6)
    v_mfma_f32_32x32x16_bf16 v[16:31], v[108:111], v[92:95], v[16:31]
    ds_read_b128 v[60:63], v6 offset:35840
    ds_read_b128 v[76:79], v8 offset:35840
    buffer_load_dwordx4 v1, s[4:7], s42 offen offset:3072 sc1 lds
    s_add_u32 s34, s34, 4096
    s_cmp_eq_u32 s34, 86016
    s_cselect_b32 s34, 0, s34
    s_waitcnt vmcnt(8)
    s_barrier
    s_waitcnt lgkmcnt(6)
    v_mfma_f32_32x32x16_bf16 v[16:31], v[64:67], v[48:51], v[16:31]
    ds_read_b128 v[80:83], v7 offset:0
    ds_read_b128 v[96:99], v9 offset:0
    s_add_u32 m0, s35, 0
    s_add_u32 s42, s40, s34
    buffer_load_dwordx4 v1, s[4:7], s42 offen offset:0 sc1 lds
    s_waitcnt lgkmcnt(6)
    v_mfma_f32_32x32x16_bf16 v[16:31], v[68:71], v[52:55], v[16:31]
    ds_read_b128 v[84:87], v7 offset:1024
    ds_read_b128 v[100:103], v9 offset:1024
    buffer_load_dwordx4 v1, s[4:7], s42 offen offset:1024 sc1 lds
    s_waitcnt lgkmcnt(6)
    v_mfma_f32_32x32x16_bf16 v[16:31], v[72:75], v[56:59], v[16:31]
    ds_read_b128 v[88:91], v7 offset:2048
    ds_read_b128 v[104:107], v9 offset:2048
    buffer_load_dwordx4 v1, s[4:7], s42 offen offset:2048 sc1 lds
    s_waitcnt lgkmcnt(6)
    v_mfma_f32_32x32x16_bf16 v[16:31], v[76:79], v[60:63], v[16:31]
    ds_read_b128 v[92:95], v7 offset:3072
    ds_read_b128 v[108:111], v9 offset:3072
    buffer_load_dwordx4 v1, s[4:7], s42 offen offset:3072 sc1 lds
    s_add_u32 s34, s34, 4096
    s_cmp_eq_u32 s34, 86016
    s_cselect_b32 s34, 0, s34
    s_waitcnt vmcnt(8)
    s_barrier
    s_waitcnt lgkmcnt(6)
    v_mfma_f32_32x32x16_bf16 v[16:31], v[96:99], v[80:83], v[16:31]
    ds_read_b128 v[48:51], v7 offset:16384
    ds_read_b128 v[64:67], v9 offset:16384
    s_add_u32 m0, s35, 16384
    s_add_u32 s42, s40, s34
    buffer_load_dwordx4 v1, s[4:7], s42 offen offset:0 sc1 lds
    s_waitcnt lgkmcnt(6)
    v_mfma_f32_32x32x16_bf16 v[16:31], v[100:103], v[84:87], v[16:31]
    ds_read_b128 v[52:55], v7 offset:17408
    ds_read_b128 v[68:71], v9 offset:17408
    buffer_load_dwordx4 v1, s[4:7], s42 offen offset:1024 sc1 lds
    s_waitcnt lgkmcnt(6)
    v_mfma_f32_32x32x16_bf16 v[16:31], v[104:107], v[88:91], v[16:31]
    ds_read_b128 v[56:59], v7 offset:18432
    ds_read_b128 v[72:75], v9 offset:18432
    buffer_load_dwordx4 v1, s[4:7], s42 offen offset:2048 sc1 lds
    s_waitcnt lgkmcnt(6)
    v_mfma_f32_32x32x16_bf16 v[16:31], v[108:111], v[92:95], v[16:31]
    ds_read_b128 v[60:63], v7 offset:19456
    ds_read_b128 v[76:79], v9 offset:19456
    buffer_load_dwordx4 v1, s[4:7], s42 offen offset:3072 sc1 lds
    s_add_u32 s34, s34, 4096
    s_cmp_eq_u32 s34, 86016
    s_cselect_b32 s34, 0, s34
    s_waitcnt vmcnt(8)
    s_barrier
    s_waitcnt lgkmcnt(6)
    v_mfma_f32_32x32x16_bf16 v[16:31], v[64:67], v[48:51], v[16:31]
    ds_read_b128 v[80:83], v7 offset:32768
    ds_read_b128 v[96:99], v9 offset:32768
    s_add_u32 m0, s35, 32768
    s_add_u32 s42, s40, s34
    buffer_load_dwordx4 v1, s[4:7], s42 offen offset:0 sc1 lds
    s_waitcnt lgkmcnt(6)
    v_mfma_f32_32x32x16_bf16 v[16:31], v[68:71], v[52:55], v[16:31]
    ds_read_b128 v[84:87], v7 offset:33792
    ds_read_b128 v[100:103], v9 offset:33792
    buffer_load_dwordx4 v1, s[4:7], s42 offen offset:1024 sc1 lds
    s_waitcnt lgkmcnt(6)
    v_mfma_f32_32x32x16_bf16 v[16:31], v[72:75], v[56:59], v[16:31]
    ds_read_b128 v[88:91], v7 offset:34816
    ds_read_b128 v[104:107], v9 offset:34816
    buffer_load_dwordx4 v1, s[4:7], s42 offen offset:2048 sc1 lds
    s_waitcnt lgkmcnt(6)
    v_mfma_f32_32x32x16_bf16 v[16:31], v[76:79], v[60:63], v[16:31]
    ds_read_b128 v[92:95], v7 offset:35840
    ds_read_b128 v[108:111], v9 offset:35840
    buffer_load_dwordx4 v1, s[4:7], s42 offen offset:3072 sc1 lds
    s_waitcnt vmcnt(8)
    s_barrier
    s_waitcnt lgkmcnt(6)
    v_mfma_f32_32x32x16_bf16 v[16:31], v[96:99], v[80:83], v[16:31]
    ds_read_b128 v[48:51], v6 offset:0
    ds_read_b128 v[64:67], v8 offset:0
    s_add_u32 m0, s35, 49152
    s_add_u32 s42, s40, 86016
    buffer_load_dwordx4 v1, s[4:7], s42 offen offset:0 sc1 lds
    s_waitcnt lgkmcnt(6)
    v_mfma_f32_32x32x16_bf16 v[16:31], v[100:103], v[84:87], v[16:31]
    ds_read_b128 v[52:55], v6 offset:1024
    ds_read_b128 v[68:71], v8 offset:1024
    buffer_load_dwordx4 v1, s[4:7], s42 offen offset:1024 sc1 lds
    s_waitcnt lgkmcnt(6)
    v_mfma_f32_32x32x16_bf16 v[16:31], v[104:107], v[88:91], v[16:31]
    ds_read_b128 v[56:59], v6 offset:2048
    ds_read_b128 v[72:75], v8 offset:2048
    s_waitcnt lgkmcnt(6)
    v_mfma_f32_32x32x16_bf16 v[16:31], v[108:111], v[92:95], v[16:31]
    ds_read_b128 v[60:63], v6 offset:3072
    ds_read_b128 v[76:79], v8 offset:3072
    s_waitcnt vmcnt(6)
    s_barrier
    s_waitcnt lgkmcnt(6)
    v_mfma_f32_32x32x16_bf16 v[16:31], v[64:67], v[48:51], v[16:31]
    ds_read_b128 v[80:83], v6 offset:16384
    ds_read_b128 v[96:99], v8 offset:16384
    s_waitcnt lgkmcnt(6)
    v_mfma_f32_32x32x16_bf16 v[16:31], v[68:71], v[52:55], v[16:31]
    ds_read_b128 v[84:87], v6 offset:17408
    ds_read_b128 v[100:103], v8 offset:17408
    s_waitcnt lgkmcnt(6)
    v_mfma_f32_32x32x16_bf16 v[16:31], v[72:75], v[56:59], v[16:31]
    ds_read_b128 v[88:91], v6 offset:18432
    ds_read_b128 v[104:107], v8 offset:18432
    s_waitcnt lgkmcnt(6)
    v_mfma_f32_32x32x16_bf16 v[16:31], v[76:79], v[60:63], v[16:31]
    ds_read_b128 v[92:95], v6 offset:19456
    ds_read_b128 v[108:111], v8 offset:19456
    s_waitcnt vmcnt(2)
    s_barrier
    s_waitcnt lgkmcnt(6)
    v_mfma_f32_32x32x16_bf16 v[16:31], v[96:99], v[80:83], v[16:31]
    ds_read_b128 v[48:51], v6 offset:32768
    ds_read_b128 v[64:67], v8 offset:32768
    s_waitcnt lgkmcnt(6)
    v_mfma_f32_32x32x16_bf16 v[16:31], v[100:103], v[84:87], v[16:31]
    ds_read_b128 v[52:55], v6 offset:33792
    ds_read_b128 v[68:71], v8 offset:33792
    s_waitcnt lgkmcnt(6)
    v_mfma_f32_32x32x16_bf16 v[16:31], v[104:107], v[88:91], v[16:31]
    ds_read_b128 v[56:59], v6 offset:34816
    ds_read_b128 v[72:75], v8 offset:34816
    s_waitcnt lgkmcnt(6)
    v_mfma_f32_32x32x16_bf16 v[16:31], v[108:111], v[92:95], v[16:31]
    ds_read_b128 v[60:63], v6 offset:35840
    ds_read_b128 v[76:79], v8 offset:35840
    s_waitcnt vmcnt(0)
    s_barrier
    s_waitcnt lgkmcnt(6)
    v_mfma_f32_32x32x16_bf16 v[16:31], v[64:67], v[48:51], v[16:31]
    ds_read_b128 v[80:83], v7 offset:0
    s_waitcnt lgkmcnt(5)
    v_mfma_f32_32x32x16_bf16 v[16:31], v[68:71], v[52:55], v[16:31]
    ds_read_b128 v[96:99], v9 offset:0
    s_waitcnt lgkmcnt(4)
    v_mfma_f32_32x32x16_bf16 v[16:31], v[72:75], v[56:59], v[16:31]
    ds_read_b128 v[84:87], v7 offset:1024
    s_waitcnt lgkmcnt(3)
    v_mfma_f32_32x32x16_bf16 v[16:31], v[76:79], v[60:63], v[16:31]
    ds_read_b128 v[100:103], v9 offset:1024
    s_waitcnt lgkmcnt(2)
    v_mfma_f32_32x32x16_bf16 v[16:31], v[96:99], v[80:83], v[16:31]
    s_waitcnt lgkmcnt(0)
    v_mfma_f32_32x32x16_bf16 v[16:31], v[100:103], v[84:87], v[16:31]
    s_add_u32 s45, s44, 3973120
    v_lshlrev_b32 v6, 10, v5
    v_lshl_add_u32 v6, v4, 4, v6
    s_lshl_b32 s48, s16, 15
    s_lshl_b32 s47, s17, 6
    s_add_u32 s48, s48, s47
    v_lshlrev_b32 v7, 4, v5
    v_lshl_add_u32 v7, v4, 2, v7
    s_lshl_b32 s46, s16, 12
    s_bfe_u32 s47, s17, 0x20001
    s_lshl_b32 s47, s47, 10
    s_add_u32 s46, s46, s47
    s_lshr_b32 s47, s17, 3
    s_lshl_b32 s47, s47, 9
    s_add_u32 s46, s46, s47
    s_and_b32 s47, s17, 1
    s_lshl_b32 s47, s47, 3
    s_add_u32 s46, s46, s47
    s_add_u32 s46, s46, 8167424
    s_cmp_lg_u32 s59, 0
    s_cselect_b32 s45, 0x7ff00000, s45
    s_cselect_b32 s46, 0x7ff00000, s46
    s_cselect_b32 s48, s48, 0x7ff00000
    s_nop 10
    v_add_f32 v16, v16, v176
    v_add_f32 v17, v17, v177
    v_add_f32 v18, v18, v178
    v_add_f32 v19, v19, v179
    v_add_f32 v20, v20, v180
    v_add_f32 v21, v21, v181
    v_add_f32 v22, v22, v182
    v_add_f32 v23, v23, v183
    v_add_f32 v24, v24, v184
    v_add_f32 v25, v25, v185
    v_add_f32 v26, v26, v186
    v_add_f32 v27, v27, v187
    v_add_f32 v28, v28, v188
    v_add_f32 v29, v29, v189
    v_add_f32 v30, v30, v190
    v_add_f32 v31, v31, v191
    v_cvt_pk_bf16_f32 v48, v16, v17
    v_cvt_pk_bf16_f32 v49, v18, v19
    v_cvt_pk_bf16_f32 v50, v20, v21
    v_cvt_pk_bf16_f32 v51, v22, v23
    v_cvt_pk_bf16_f32 v52, v24, v25
    v_cvt_pk_bf16_f32 v53, v26, v27
    v_cvt_pk_bf16_f32 v54, v28, v29
    v_cvt_pk_bf16_f32 v55, v30, v31
    buffer_store_dwordx4 v[48:51], v1, s[4:7], s45 offen
    buffer_store_dwordx4 v[52:55], v1, s[4:7], s45 offen offset:1024
    v_mov_b32 v56, v48
    v_mov_b32 v57, v49
    v_mov_b32 v58, v50
    v_mov_b32 v59, v51
    v_mov_b32 v60, v52
    v_mov_b32 v61, v53
    v_mov_b32 v62, v54
    v_mov_b32 v63, v55
    v_permlane32_swap_b32 v56, v58
    v_permlane32_swap_b32 v57, v59
    s_nop 0
    v_permlane32_swap_b32 v60, v62
    v_permlane32_swap_b32 v61, v63
    s_nop 1
    buffer_store_dwordx4 v[56:59], v6, s[12:15], s48 offen
    buffer_store_dwordx4 v[60:63], v6, s[12:15], s48 offen offset:32
    v_add_f32 v12, v16, v17
    v_mul_f32 v13, v16, v16
    v_fma_f32 v13, v17, v17, v13
    v_add_f32 v12, v12, v18
    v_fma_f32 v13, v18, v18, v13
    v_add_f32 v12, v12, v19
    v_fma_f32 v13, v19, v19, v13
    v_add_f32 v12, v12, v20
    v_fma_f32 v13, v20, v20, v13
    v_add_f32 v12, v12, v21
    v_fma_f32 v13, v21, v21, v13
    v_add_f32 v12, v12, v22
    v_fma_f32 v13, v22, v22, v13
    v_add_f32 v12, v12, v23
    v_fma_f32 v13, v23, v23, v13
    v_add_f32 v12, v12, v24
    v_fma_f32 v13, v24, v24, v13
    v_add_f32 v12, v12, v25
    v_fma_f32 v13, v25, v25, v13
    v_add_f32 v12, v12, v26
    v_fma_f32 v13, v26, v26, v13
    v_add_f32 v12, v12, v27
    v_fma_f32 v13, v27, v27, v13
    v_add_f32 v12, v12, v28
    v_fma_f32 v13, v28, v28, v13
    v_add_f32 v12, v12, v29
    v_fma_f32 v13, v29, v29, v13
    v_add_f32 v12, v12, v30
    v_fma_f32 v13, v30, v30, v13
    v_add_f32 v12, v12, v31
    v_fma_f32 v13, v31, v31, v13
    s_nop 1
    v_permlane32_swap_b32 v12, v13
    s_nop 1
    v_add_f32 v12, v12, v13
    buffer_store_dword v12, v7, s[4:7], s46 offen
attn_kernel_end:
    s_endpgm
attn_kernel_slow:
    s_mov_b32 s35, 10788864
    s_mov_b32 s36, 64
    v_mov_b32 v160, 0xff800000
    v_mov_b32 v161, 0xff800000
    v_mov_b32 v162, 0xff800000
    v_mov_b32 v163, 0xff800000
attn_kernel_mx2:
    buffer_load_dwordx4 v[148:151], v1, s[4:7], s35 offen sc1
    s_waitcnt vmcnt(0)
    v_mfma_f32_32x32x16_bf16 v[96:111], v[148:151], v[16:19], 0
    v_mfma_f32_32x32x16_bf16 v[112:127], v[148:151], v[20:23], 0
    s_nop 15
    s_nop 3
    v_max3_f32 v160, v160, v96, v97
    v_max3_f32 v160, v160, v98, v99
    v_max3_f32 v160, v160, v100, v101
    v_max3_f32 v160, v160, v102, v103
    v_max3_f32 v160, v160, v104, v105
    v_max3_f32 v160, v160, v106, v107
    v_max3_f32 v160, v160, v108, v109
    v_max3_f32 v160, v160, v110, v111
    v_max3_f32 v161, v161, v112, v113
    v_max3_f32 v161, v161, v114, v115
    v_max3_f32 v161, v161, v116, v117
    v_max3_f32 v161, v161, v118, v119
    v_max3_f32 v161, v161, v120, v121
    v_max3_f32 v161, v161, v122, v123
    v_max3_f32 v161, v161, v124, v125
    v_max3_f32 v161, v161, v126, v127
    v_mfma_f32_32x32x16_bf16 v[96:111], v[148:151], v[24:27], 0
    v_mfma_f32_32x32x16_bf16 v[112:127], v[148:151], v[28:31], 0
    s_nop 15
    s_nop 3
    v_max3_f32 v162, v162, v96, v97
    v_max3_f32 v162, v162, v98, v99
    v_max3_f32 v162, v162, v100, v101
    v_max3_f32 v162, v162, v102, v103
    v_max3_f32 v162, v162, v104, v105
    v_max3_f32 v162, v162, v106, v107
    v_max3_f32 v162, v162, v108, v109
    v_max3_f32 v162, v162, v110, v111
    v_max3_f32 v163, v163, v112, v113
    v_max3_f32 v163, v163, v114, v115
    v_max3_f32 v163, v163, v116, v117
    v_max3_f32 v163, v163, v118, v119
    v_max3_f32 v163, v163, v120, v121
    v_max3_f32 v163, v163, v122, v123
    v_max3_f32 v163, v163, v124, v125
    v_max3_f32 v163, v163, v126, v127
    s_add_u32 s35, s35, 1024
    s_sub_u32 s36, s36, 1
    s_cmp_lg_u32 s36, 0
    s_cbranch_scc1 attn_kernel_mx2
    v_mov_b32 v8, v160
    v_mov_b32 v9, v161
    v_mov_b32 v10, v162
    v_mov_b32 v11, v163
    s_nop 1
    v_permlane32_swap_b32 v8, v160
    v_permlane32_swap_b32 v9, v161
    v_permlane32_swap_b32 v10, v162
    v_permlane32_swap_b32 v11, v163
    s_nop 1
    v_max_f32 v160, v160, v8
    v_max_f32 v161, v161, v9
    v_max_f32 v162, v162, v10
    v_max_f32 v163, v163, v11
    v_mov_b32 v124, 0
    v_mov_b32 v125, 0
    v_mov_b32 v126, 0
    v_mov_b32 v127, 0
    buffer_load_dwordx4 a[0:3], v1, s[4:7], s43 offen offset:0
    buffer_load_dwordx4 a[4:7], v1, s[4:7], s43 offen offset:1024
    buffer_load_dwordx4 a[8:11], v1, s[4:7], s43 offen offset:2048
    buffer_load_dwordx4 a[12:15], v1, s[4:7], s43 offen offset:3072
    s_add_u32 s53, s53, 8192
    s_and_b32 s53, s53, 0x7fff
    s_add_u32 s43, s52, s53
    buffer_load_dwordx4 a[16:19], v1, s[4:7], s43 offen offset:0
    buffer_load_dwordx4 a[20:23], v1, s[4:7], s43 offen offset:1024
    buffer_load_dwordx4 a[24:27], v1, s[4:7], s43 offen offset:2048
    buffer_load_dwordx4 a[28:31], v1, s[4:7], s43 offen offset:3072
    s_add_u32 s53, s53, 8192
    s_and_b32 s53, s53, 0x7fff
    s_add_u32 s43, s52, s53
    buffer_load_dwordx4 a[32:35], v1, s[4:7], s43 offen offset:0
    buffer_load_dwordx4 a[36:39], v1, s[4:7], s43 offen offset:1024
    buffer_load_dwordx4 a[40:43], v1, s[4:7], s43 offen offset:2048
    buffer_load_dwordx4 a[44:47], v1, s[4:7], s43 offen offset:3072
    s_add_u32 s53, s53, 8192
    s_and_b32 s53, s53, 0x7fff
    s_add_u32 s43, s52, s53
    buffer_load_dwordx4 a[48:51], v1, s[4:7], s43 offen offset:0
    buffer_load_dwordx4 a[52:55], v1, s[4:7], s43 offen offset:1024
    buffer_load_dwordx4 a[56:59], v1, s[4:7], s43 offen offset:2048
    buffer_load_dwordx4 a[60:63], v1, s[4:7], s43 offen offset:3072
    s_add_u32 s53, s53, 8192
    s_and_b32 s53, s53, 0x7fff
    s_add_u32 s43, s52, s53
    s_waitcnt vmcnt(0)
    v_mfma_f32_32x32x16_bf16 v[96:111], v[136:139], v[16:19], 0
    s_nop 15
    .p2align 6
attn_kernel_loop3:
    v_sub_f32 v96, v96, v160
    v_exp_f32 v96, v96
    v_sub_f32 v97, v97, v160
    v_exp_f32 v97, v97
    v_cvt_pk_bf16_f32 v134, v124, v125
    v_sub_f32 v98, v98, v160
    v_exp_f32 v98, v98
    v_cvt_pk_bf16_f32 v135, v126, v127
    v_mfma_f32_32x32x16_bf16 v[112:127], v[136:139], v[20:23], 0
    v_sub_f32 v99, v99, v160
    v_exp_f32 v99, v99
    v_sub_f32 v100, v100, v160
    v_exp_f32 v100, v100
    v_cvt_pk_bf16_f32 v128, v96, v97
    v_mfma_f32_32x32x16_bf16 v[80:95], v[156:159], v[132:135], v[80:95]
    buffer_load_dwordx4 v[148:151], v1, s[4:7], s40 offen offset:0 sc1
    buffer_load_dwordx4 v[152:155], v1, s[4:7], s41 offen offset:0 sc1
    buffer_load_dwordx4 v[156:159], v1, s[4:7], s41 offen offset:1024 sc1
    v_sub_f32 v101, v101, v160
    v_exp_f32 v101, v101
    v_sub_f32 v102, v102, v160
    v_exp_f32 v102, v102
    v_cvt_pk_bf16_f32 v129, v98, v99
    v_sub_f32 v103, v103, v160
    v_exp_f32 v103, v103
    v_sub_f32 v104, v104, v160
    v_exp_f32 v104, v104
    v_cvt_pk_bf16_f32 v130, v100, v101
    v_sub_f32 v105, v105, v160
    v_exp_f32 v105, v105
    v_sub_f32 v106, v106, v160
    v_exp_f32 v106, v106
    v_cvt_pk_bf16_f32 v131, v102, v103
    v_sub_f32 v107, v107, v160
    v_exp_f32 v107, v107
    v_sub_f32 v108, v108, v160
    v_exp_f32 v108, v108
    v_mfma_f32_32x32x16_bf16 v[32:47], v[140:143], v[128:131], v[32:47]
    v_cvt_pk_bf16_f32 v132, v104, v105
    v_sub_f32 v109, v109, v160
    v_exp_f32 v109, v109
    v_sub_f32 v110, v110, v160
    v_exp_f32 v110, v110
    v_cvt_pk_bf16_f32 v133, v106, v107
    v_sub_f32 v111, v111, v160
    v_exp_f32 v111, v111
    v_sub_f32 v112, v112, v161
    v_exp_f32 v112, v112
    v_sub_f32 v113, v113, v161
    v_exp_f32 v113, v113
    v_cvt_pk_bf16_f32 v134, v108, v109
    v_sub_f32 v114, v114, v161
    v_exp_f32 v114, v114
    v_cvt_pk_bf16_f32 v135, v110, v111
    v_mfma_f32_32x32x16_bf16 v[96:111], v[136:139], v[24:27], 0
    v_sub_f32 v115, v115, v161
    v_exp_f32 v115, v115
    v_sub_f32 v116, v116, v161
    v_exp_f32 v116, v116
    v_cvt_pk_bf16_f32 v128, v112, v113
    v_mfma_f32_32x32x16_bf16 v[32:47], v[144:147], v[132:135], v[32:47]
    v_sub_f32 v117, v117, v161
    v_exp_f32 v117, v117
    v_sub_f32 v118, v118, v161
    v_exp_f32 v118, v118
    v_cvt_pk_bf16_f32 v129, v114, v115
    v_sub_f32 v119, v119, v161
    v_exp_f32 v119, v119
    v_sub_f32 v120, v120, v161
    v_exp_f32 v120, v120
    v_cvt_pk_bf16_f32 v130, v116, v117
    v_sub_f32 v121, v121, v161
    v_exp_f32 v121, v121
    v_sub_f32 v122, v122, v161
    v_exp_f32 v122, v122
    v_cvt_pk_bf16_f32 v131, v118, v119
    v_sub_f32 v123, v123, v161
    v_exp_f32 v123, v123
    v_sub_f32 v124, v124, v161
    v_exp_f32 v124, v124
    v_mfma_f32_32x32x16_bf16 v[48:63], v[140:143], v[128:131], v[48:63]
    v_cvt_pk_bf16_f32 v132, v120, v121
    v_sub_f32 v125, v125, v161
    v_exp_f32 v125, v125
    v_sub_f32 v126, v126, v161
    v_exp_f32 v126, v126
    v_cvt_pk_bf16_f32 v133, v122, v123
    v_sub_f32 v127, v127, v161
    v_exp_f32 v127, v127
    v_sub_f32 v96, v96, v162
    v_exp_f32 v96, v96
    v_sub_f32 v97, v97, v162
    v_exp_f32 v97, v97
    v_cvt_pk_bf16_f32 v134, v124, v125
    v_sub_f32 v98, v98, v162
    v_exp_f32 v98, v98
    v_cvt_pk_bf16_f32 v135, v126, v127
    v_mfma_f32_32x32x16_bf16 v[112:127], v[136:139], v[28:31], 0
    v_sub_f32 v99, v99, v162
    v_exp_f32 v99, v99
    v_sub_f32 v100, v100, v162
    v_exp_f32 v100, v100
    v_cvt_pk_bf16_f32 v128, v96, v97
    v_mfma_f32_32x32x16_bf16 v[48:63], v[144:147], v[132:135], v[48:63]
    v_sub_f32 v101, v101, v162
    v_exp_f32 v101, v101
    v_sub_f32 v102, v102, v162
    v_exp_f32 v102, v102
    v_cvt_pk_bf16_f32 v129, v98, v99
    v_sub_f32 v103, v103, v162
    v_exp_f32 v103, v103
    v_sub_f32 v104, v104, v162
    v_exp_f32 v104, v104
    v_cvt_pk_bf16_f32 v130, v100, v101
    v_sub_f32 v105, v105, v162
    v_exp_f32 v105, v105
    v_sub_f32 v106, v106, v162
    v_exp_f32 v106, v106
    v_cvt_pk_bf16_f32 v131, v102, v103
    v_sub_f32 v107, v107, v162
    v_exp_f32 v107, v107
    v_sub_f32 v108, v108, v162
    v_exp_f32 v108, v108
    v_mfma_f32_32x32x16_bf16 v[64:79], v[140:143], v[128:131], v[64:79]
    v_cvt_pk_bf16_f32 v132, v104, v105
    v_sub_f32 v109, v109, v162
    v_exp_f32 v109, v109
    v_sub_f32 v110, v110, v162
    v_exp_f32 v110, v110
    v_cvt_pk_bf16_f32 v133, v106, v107
    v_sub_f32 v111, v111, v162
    v_exp_f32 v111, v111
    v_sub_f32 v112, v112, v163
    v_exp_f32 v112, v112
    v_sub_f32 v113, v113, v163
    v_exp_f32 v113, v113
    v_cvt_pk_bf16_f32 v134, v108, v109
    v_sub_f32 v114, v114, v163
    v_exp_f32 v114, v114
    v_cvt_pk_bf16_f32 v135, v110, v111
    s_waitcnt vmcnt(0)
    v_mfma_f32_32x32x16_bf16 v[96:111], v[148:151], v[16:19], 0
    v_sub_f32 v115, v115, v163
    v_exp_f32 v115, v115
    v_sub_f32 v116, v116, v163
    v_exp_f32 v116, v116
    v_cvt_pk_bf16_f32 v128, v112, v113
    v_mfma_f32_32x32x16_bf16 v[64:79], v[144:147], v[132:135], v[64:79]
    v_sub_f32 v117, v117, v163
    v_exp_f32 v117, v117
    v_sub_f32 v118, v118, v163
    v_exp_f32 v118, v118
    v_cvt_pk_bf16_f32 v129, v114, v115
    v_sub_f32 v119, v119, v163
    v_exp_f32 v119, v119
    v_sub_f32 v120, v120, v163
    v_exp_f32 v120, v120
    v_cvt_pk_bf16_f32 v130, v116, v117
    v_sub_f32 v121, v121, v163
    v_exp_f32 v121, v121
    v_sub_f32 v122, v122, v163
    v_exp_f32 v122, v122
    v_cvt_pk_bf16_f32 v131, v118, v119
    v_sub_f32 v123, v123, v163
    v_exp_f32 v123, v123
    v_sub_f32 v124, v124, v163
    v_exp_f32 v124, v124
    v_mfma_f32_32x32x16_bf16 v[80:95], v[140:143], v[128:131], v[80:95]
    v_cvt_pk_bf16_f32 v132, v120, v121
    v_sub_f32 v125, v125, v163
    v_exp_f32 v125, v125
    v_sub_f32 v126, v126, v163
    v_exp_f32 v126, v126
    v_cvt_pk_bf16_f32 v133, v122, v123
    v_sub_f32 v127, v127, v163
    v_exp_f32 v127, v127
    v_sub_f32 v96, v96, v160
    v_exp_f32 v96, v96
    v_sub_f32 v97, v97, v160
    v_exp_f32 v97, v97
    v_cvt_pk_bf16_f32 v134, v124, v125
    v_sub_f32 v98, v98, v160
    v_exp_f32 v98, v98
    v_cvt_pk_bf16_f32 v135, v126, v127
    v_mfma_f32_32x32x16_bf16 v[112:127], v[148:151], v[20:23], 0
    v_sub_f32 v99, v99, v160
    v_exp_f32 v99, v99
    v_sub_f32 v100, v100, v160
    v_exp_f32 v100, v100
    v_cvt_pk_bf16_f32 v128, v96, v97
    v_mfma_f32_32x32x16_bf16 v[80:95], v[144:147], v[132:135], v[80:95]
    buffer_load_dwordx4 v[136:139], v1, s[4:7], s40 offen offset:1024 sc1
    buffer_load_dwordx4 v[140:143], v1, s[4:7], s41 offen offset:2048 sc1
    buffer_load_dwordx4 v[144:147], v1, s[4:7], s41 offen offset:3072 sc1
    v_sub_f32 v101, v101, v160
    v_exp_f32 v101, v101
    v_sub_f32 v102, v102, v160
    v_exp_f32 v102, v102
    v_cvt_pk_bf16_f32 v129, v98, v99
    v_sub_f32 v103, v103, v160
    v_exp_f32 v103, v103
    v_sub_f32 v104, v104, v160
    v_exp_f32 v104, v104
    v_cvt_pk_bf16_f32 v130, v100, v101
    v_sub_f32 v105, v105, v160
    v_exp_f32 v105, v105
    v_sub_f32 v106, v106, v160
    v_exp_f32 v106, v106
    v_cvt_pk_bf16_f32 v131, v102, v103
    v_sub_f32 v107, v107, v160
    v_exp_f32 v107, v107
    v_sub_f32 v108, v108, v160
    v_exp_f32 v108, v108
    v_mfma_f32_32x32x16_bf16 v[32:47], v[152:155], v[128:131], v[32:47]
    v_cvt_pk_bf16_f32 v132, v104, v105
    v_sub_f32 v109, v109, v160
    v_exp_f32 v109, v109
    v_sub_f32 v110, v110, v160
    v_exp_f32 v110, v110
    v_cvt_pk_bf16_f32 v133, v106, v107
    v_sub_f32 v111, v111, v160
    v_exp_f32 v111, v111
    v_sub_f32 v112, v112, v161
    v_exp_f32 v112, v112
    v_sub_f32 v113, v113, v161
    v_exp_f32 v113, v113
    v_cvt_pk_bf16_f32 v134, v108, v109
    v_sub_f32 v114, v114, v161
    v_exp_f32 v114, v114
    v_cvt_pk_bf16_f32 v135, v110, v111
    v_mfma_f32_32x32x16_bf16 v[96:111], v[148:151], v[24:27], 0
    v_sub_f32 v115, v115, v161
    v_exp_f32 v115, v115
    v_sub_f32 v116, v116, v161
    v_exp_f32 v116, v116
    v_cvt_pk_bf16_f32 v128, v112, v113
    v_mfma_f32_32x32x16_bf16 v[32:47], v[156:159], v[132:135], v[32:47]
    v_sub_f32 v117, v117, v161
    v_exp_f32 v117, v117
    v_sub_f32 v118, v118, v161
    v_exp_f32 v118, v118
    v_cvt_pk_bf16_f32 v129, v114, v115
    v_sub_f32 v119, v119, v161
    v_exp_f32 v119, v119
    v_sub_f32 v120, v120, v161
    v_exp_f32 v120, v120
    v_cvt_pk_bf16_f32 v130, v116, v117
    v_sub_f32 v121, v121, v161
    v_exp_f32 v121, v121
    v_sub_f32 v122, v122, v161
    v_exp_f32 v122, v122
    v_cvt_pk_bf16_f32 v131, v118, v119
    v_sub_f32 v123, v123, v161
    v_exp_f32 v123, v123
    v_sub_f32 v124, v124, v161
    v_exp_f32 v124, v124
    v_mfma_f32_32x32x16_bf16 v[48:63], v[152:155], v[128:131], v[48:63]
    v_cvt_pk_bf16_f32 v132, v120, v121
    v_sub_f32 v125, v125, v161
    v_exp_f32 v125, v125
    v_sub_f32 v126, v126, v161
    v_exp_f32 v126, v126
    v_cvt_pk_bf16_f32 v133, v122, v123
    v_sub_f32 v127, v127, v161
    v_exp_f32 v127, v127
    v_sub_f32 v96, v96, v162
    v_exp_f32 v96, v96
    v_sub_f32 v97, v97, v162
    v_exp_f32 v97, v97
    v_cvt_pk_bf16_f32 v134, v124, v125
    v_sub_f32 v98, v98, v162
    v_exp_f32 v98, v98
    v_cvt_pk_bf16_f32 v135, v126, v127
    v_mfma_f32_32x32x16_bf16 v[112:127], v[148:151], v[28:31], 0
    v_sub_f32 v99, v99, v162
    v_exp_f32 v99, v99
    v_sub_f32 v100, v100, v162
    v_exp_f32 v100, v100
    v_cvt_pk_bf16_f32 v128, v96, v97
    v_mfma_f32_32x32x16_bf16 v[48:63], v[156:159], v[132:135], v[48:63]
    v_sub_f32 v101, v101, v162
    v_exp_f32 v101, v101
    v_sub_f32 v102, v102, v162
    v_exp_f32 v102, v102
    v_cvt_pk_bf16_f32 v129, v98, v99
    v_sub_f32 v103, v103, v162
    v_exp_f32 v103, v103
    v_sub_f32 v104, v104, v162
    v_exp_f32 v104, v104
    v_cvt_pk_bf16_f32 v130, v100, v101
    v_sub_f32 v105, v105, v162
    v_exp_f32 v105, v105
    v_sub_f32 v106, v106, v162
    v_exp_f32 v106, v106
    v_cvt_pk_bf16_f32 v131, v102, v103
    v_sub_f32 v107, v107, v162
    v_exp_f32 v107, v107
    v_sub_f32 v108, v108, v162
    v_exp_f32 v108, v108
    v_mfma_f32_32x32x16_bf16 v[64:79], v[152:155], v[128:131], v[64:79]
    v_cvt_pk_bf16_f32 v132, v104, v105
    v_sub_f32 v109, v109, v162
    v_exp_f32 v109, v109
    v_sub_f32 v110, v110, v162
    v_exp_f32 v110, v110
    v_cvt_pk_bf16_f32 v133, v106, v107
    v_sub_f32 v111, v111, v162
    v_exp_f32 v111, v111
    v_sub_f32 v112, v112, v163
    v_exp_f32 v112, v112
    v_sub_f32 v113, v113, v163
    v_exp_f32 v113, v113
    v_cvt_pk_bf16_f32 v134, v108, v109
    v_sub_f32 v114, v114, v163
    v_exp_f32 v114, v114
    v_cvt_pk_bf16_f32 v135, v110, v111
    s_waitcnt vmcnt(0)
    v_mfma_f32_32x32x16_bf16 v[96:111], v[136:139], v[16:19], 0
    v_sub_f32 v115, v115, v163
    v_exp_f32 v115, v115
    v_sub_f32 v116, v116, v163
    v_exp_f32 v116, v116
    v_cvt_pk_bf16_f32 v128, v112, v113
    v_mfma_f32_32x32x16_bf16 v[64:79], v[156:159], v[132:135], v[64:79]
    v_sub_f32 v117, v117, v163
    v_exp_f32 v117, v117
    v_sub_f32 v118, v118, v163
    v_exp_f32 v118, v118
    v_cvt_pk_bf16_f32 v129, v114, v115
    v_sub_f32 v119, v119, v163
    v_exp_f32 v119, v119
    v_sub_f32 v120, v120, v163
    v_exp_f32 v120, v120
    v_cvt_pk_bf16_f32 v130, v116, v117
    v_sub_f32 v121, v121, v163
    v_exp_f32 v121, v121
    v_sub_f32 v122, v122, v163
    v_exp_f32 v122, v122
    v_cvt_pk_bf16_f32 v131, v118, v119
    v_sub_f32 v123, v123, v163
    v_exp_f32 v123, v123
    v_sub_f32 v124, v124, v163
    v_exp_f32 v124, v124
    v_mfma_f32_32x32x16_bf16 v[80:95], v[152:155], v[128:131], v[80:95]
    v_cvt_pk_bf16_f32 v132, v120, v121
    v_sub_f32 v125, v125, v163
    v_exp_f32 v125, v125
    v_sub_f32 v126, v126, v163
    v_exp_f32 v126, v126
    v_cvt_pk_bf16_f32 v133, v122, v123
    v_sub_f32 v127, v127, v163
    v_exp_f32 v127, v127
    s_add_u32 s40, s40, 2048
    s_add_u32 s41, s41, 4096
    s_sub_u32 s34, s34, 1
    s_cmp_lg_u32 s34, 0
    s_cbranch_scc1 attn_kernel_loop3
    s_nop 0
    v_cvt_pk_bf16_f32 v134, v124, v125
    v_cvt_pk_bf16_f32 v135, v126, v127
    s_nop 1
    v_mfma_f32_32x32x16_bf16 v[80:95], v[156:159], v[132:135], v[80:95]
    s_branch attn_kernel_fin
.section .rodata,"a"
.p2align 6
.amdhsa_kernel prep_kernel
  .amdhsa_next_free_vgpr 64
  .amdhsa_next_free_sgpr 96
  .amdhsa_accum_offset 64
  .amdhsa_group_segment_fixed_size 0
  .amdhsa_kernarg_size 104
  .amdhsa_user_sgpr_count 2
  .amdhsa_user_sgpr_kernarg_segment_ptr 1
  .amdhsa_system_sgpr_workgroup_id_x 1
.end_amdhsa_kernel
.p2align 6
.amdhsa_kernel layer2_kernel
  .amdhsa_next_free_vgpr 256
  .amdhsa_next_free_sgpr 96
  .amdhsa_accum_offset 192
  .amdhsa_group_segment_fixed_size 0
  .amdhsa_kernarg_size 104
  .amdhsa_user_sgpr_count 2
  .amdhsa_user_sgpr_kernarg_segment_ptr 1
  .amdhsa_system_sgpr_workgroup_id_x 1
.end_amdhsa_kernel
.p2align 6
.amdhsa_kernel attn_kernel
  .amdhsa_next_free_vgpr 256
  .amdhsa_next_free_sgpr 96
  .amdhsa_accum_offset 192
  .amdhsa_group_segment_fixed_size 0
  .amdhsa_kernarg_size 104
  .amdhsa_user_sgpr_count 2
  .amdhsa_user_sgpr_kernarg_segment_ptr 1
  .amdhsa_system_sgpr_workgroup_id_x 1
.end_amdhsa_kernel
```
